```python
import torch

def _softmax(x, axis=-1):
    return torch.softmax(x, dim=axis)
def _gelu(x):
    return torch.nn.functional.gelu(x, approximate="tanh")
def _silu(x):
    return torch.nn.functional.silu(x)
def _sigmoid(x):
    return torch.sigmoid(x)
def _layernorm(x, axis=-1, eps=1e-5):
    m = x.mean(dim=axis, keepdim=True)
    v = x.var(dim=axis, keepdim=True, unbiased=False)
    return (x - m) / torch.sqrt(v + eps)
def _scatter_add(tgt, idx, src, axis=0):
    return tgt.clone().index_add_(axis, idx, src)
def _segment_sum(src, seg, n):
    out = torch.zeros((n,) + src.shape[1:], dtype=src.dtype)
    return out.index_add_(0, seg, src)
def _pad(x, pw):
    flat = tuple(v for pair in reversed(pw) for v in pair)
    return torch.nn.functional.pad(x, flat)

kernel_name = 'gated_mix__linear_attn_block__dense_activation_mish__prompt'

def setup_inputs():

    _w = (lambda a: (lambda t: t.to(torch.bfloat16) if t.is_floating_point() else t)(torch.as_tensor(a)))
    def _A_setup():
        B, S, D = 1, 2048, 512
        return {
            "x": _w((lambda *s: torch.randn(*s, dtype=torch.bfloat16) * 0.05)(B, S, D)),
            "wqkv": _w((lambda *s: torch.randn(*s, dtype=torch.bfloat16) * 0.8)(D, 3 * D)),
            "wo": _w((lambda *s: torch.randn(*s, dtype=torch.bfloat16) * 0.1)(D, D)),
        }
    _A_in = _A_setup()

    def _B_setup():
        B, S, D, F = 1, 2048, 512, 1792
        return {
            "x": _w((lambda *s: torch.randn(*s, dtype=torch.bfloat16) * 0.05)(B, S, D)),
            "w1": _w((lambda *s: torch.randn(*s, dtype=torch.bfloat16) * 12.8)(D, F) * (D ** -0.5)),
            "b1": _w((lambda *s: torch.randn(*s, dtype=torch.bfloat16) * 0.4)(F)),
            "w2": _w((lambda *s: torch.randn(*s, dtype=torch.bfloat16) * 0.05)(F, D) * (F ** -0.5)),
        }
    _B_in = _B_setup()

    return {
        "A_x": _A_in["x"],
        "A_wqkv": _A_in["wqkv"],
        "A_wo": _A_in["wo"],
        "B_x": _B_in["x"],
        "B_w1": _B_in["w1"],
        "B_b1": _B_in["b1"],
        "B_w2": _B_in["w2"],
        "gate_w": _w((lambda *s: torch.randn(*s, dtype=torch.bfloat16) * 0.05)(512) * 16.0),
    }

def reference(A_x, A_wqkv, A_wo, B_x, B_w1, B_b1, B_w2, gate_w):
    def _A_ref(x, wqkv, wo):
        B, S, D = x.shape
        H = 32; Dh = D // H
        qkv = (lambda x, *d: x.permute(*d))((x @ wqkv).reshape(B, S, 3, H, Dh), 2, 0, 3, 1, 4)
        q, k, v = qkv[0], qkv[1], qkv[2]
        phi = lambda t: torch.where(t > 0, t + 1, torch.exp(t)) + 1e-6
        pq, pk = phi(q), phi(k)
        kv = torch.einsum("bhsd,bhse->bhde", pk, v)
        z = torch.einsum("bhsd->bhd", pk)
        num = torch.einsum("bhqd,bhde->bhqe", pq, kv)
        den = torch.einsum("bhqd,bhd->bhq", pq, z)[..., None] + 1e-6
        o = num / den
        return (lambda x, *d: x.permute(*d))(o, 0, 2, 1, 3).reshape(B, S, D) @ wo

    def _B_ref(x, w1, b1, w2):
        h = torch.einsum("bsd,df->bsf", x, w1) + b1
        sp = torch.log1p(torch.exp(-torch.abs(h))) + torch.where(h > 0, h, torch.zeros_like(h))
        act = h * torch.tanh(sp)
        return torch.einsum("bsf,fd->bsd", act, w2)

    x = A_x
    g = _sigmoid((x * gate_w).sum(-1, keepdims=True))
    a = _A_ref(x, A_wqkv, A_wo)
    b = _B_ref(x, B_w1, B_b1, B_w2)
    return g * a + (1 - g) * b
```

```asm
; @launch grid=(256,1,1) block=(512,1,1) lds=163840
.amdgcn_target "amdgcn-amd-amdhsa--gfx950"
.text
.globl gated_mix__linear_attn_block__dense_activation_mish__prompt_kernel
.p2align 8
.type gated_mix__linear_attn_block__dense_activation_mish__prompt_kernel,@function
gated_mix__linear_attn_block__dense_activation_mish__prompt_kernel:
    s_cmp_ge_u32 s2, 256
    s_cbranch_scc1 END
    s_load_dwordx16 s[8:23], s[0:1], 0
    s_load_dwordx4 s[24:27], s[0:1], 64
    s_load_dwordx2 s[28:29], s[0:1], 80
    s_getpc_b64 s[30:31]
    s_and_b32 s88, s2, 0xf8
    v_lshrrev_b32 v64, 6, v0
    v_add_u32 v65, s88, v64
    v_lshlrev_b32 v65, 7, v65
    v_min_u32 v65, CODE_END-gated_mix__linear_attn_block__dense_activation_mish__prompt_kernel-256, v65
    s_mov_b64 exec, 1
    global_load_dword v255, v65, s[30:31]
    s_mov_b64 exec, -1
    v_and_b32 v1, 63, v0
    v_readfirstlane_b32 s64, v64
    s_lshr_b32 s96, s2, 6
    s_bfe_u32 s94, s2, 0x30003
    s_and_b32 s66, s2, 1
    s_lshl_b32 s66, s66, 3
    s_or_b32 s66, s66, s94
    s_bfe_u32 s93, s2, 0x20001
    s_lshr_b32 s68, s96, 1
    s_and_b32 s95, s96, 1
    s_lshl_b32 s67, s93, 1
    s_or_b32 s67, s67, s95
    s_lshl_b32 s70, s95, 2
    s_xor_b32 s70, s70, s94
    s_and_b32 s65, s64, 3
    s_lshr_b32 s73, s64, 2
    s_lshl_b32 s71, s64, 10
    s_lshl_b32 s69, s68, 9
    s_add_u32 s69, s69, 3072
    s_lshl_b32 s72, s66, 17
    s_lshl_b32 s88, s70, 7
    s_or_b32 s72, s72, s88
    v_lshrrev_b32 v32, 3, v0
    v_and_b32 v65, 7, v0
    v_bfe_u32 v33, v0, 4, 3
    v_xor_b32 v33, v33, v65
    v_lshlrev_b32 v33, 4, v33
    v_lshl_add_u32 v2, v32, 10, v33
    v_bfe_u32 v33, v0, 4, 1
    v_lshlrev_b32 v33, 2, v33
    v_xor_b32 v33, v33, v65
    v_lshlrev_b32 v34, 4, v33
    v_mul_lo_u32 v69, v32, s69
    v_add_u32 v0, v69, v34
    s_mul_i32 s79, s67, 448
    s_lshl_b32 s89, s95, 6
    s_add_u32 s76, s79, s89
    s_add_u32 s77, s76, 128
    s_add_u32 s78, s76, 256
    s_cmp_eq_u32 s95, 0
    s_cselect_b32 s89, 384, 0
    s_add_u32 s79, s79, s89
    s_cmp_eq_u32 s68, 1
    s_cbranch_scc1 PRO_w1
    s_lshl_b32 s78, s67, 7
    s_add_u32 s76, s78, 1024
    s_add_u32 s77, s78, 2048
PRO_w1:
    s_lshl_b32 s101, s69, 6
    s_mul_i32 s80, s70, s101
    v_add_u32 v3, s76, v0
    v_add_u32 v4, s77, v0
    s_mov_b32 s34, 0x200000
    s_mov_b32 s35, 0x20000
    s_mov_b32 s39, 0x20000
    s_lshl_b32 s38, s69, 9
    s_mul_i32 s58, s68, 2560
    s_add_u32 s58, s58, 1024
    s_mov_b32 s59, 0x20000
    s_cmp_eq_u32 s68, 1
    s_waitcnt lgkmcnt(0)
    s_mov_b32 s32, s8
    s_cselect_b32 s36, s16, s10
    s_cselect_b32 s37, s17, s11
    s_cselect_b32 s56, s18, s22
    s_cselect_b32 s57, s19, s23
    s_and_b32 s33, s9, 0xffff
    s_and_b32 s37, s37, 0xffff
    s_and_b32 s57, s57, 0xffff
    s_add_u32 m0, s71, 0x0
    s_xor_b32 s89, s72, 0x0
    buffer_load_dwordx4 v2, s[32:35], s89 offen lds
    s_add_u32 m0, s71, 0x2000
    s_xor_b32 s89, s72, 0x10000
    buffer_load_dwordx4 v2, s[32:35], s89 offen lds
    s_add_u32 m0, s71, 0x10000
    s_nop 0
    buffer_load_dwordx4 v3, s[36:39], s80 offen lds
    s_barrier
    s_xor_b32 s81, s70, 1
    s_mul_i32 s81, s81, s101
    s_xor_b32 s82, s70, 2
    s_mul_i32 s82, s82, s101
    s_xor_b32 s83, s70, 3
    s_mul_i32 s83, s83, s101
    s_add_u32 m0, s71, 0x4000
    s_xor_b32 s89, s72, 0x80
    buffer_load_dwordx4 v2, s[32:35], s89 offen lds
    s_add_u32 m0, s71, 0x6000
    s_xor_b32 s89, s72, 0x10080
    buffer_load_dwordx4 v2, s[32:35], s89 offen lds
    s_add_u32 m0, s71, 0x12000
    s_nop 0
    buffer_load_dwordx4 v3, s[36:39], s81 offen lds
    v_and_b32 v64, 31, v1
    v_lshrrev_b32 v35, 5, v1
    v_bfe_u32 v66, v1, 1, 3
    v_xor_b32 v66, v66, v35
    s_lshl_b32 s88, s73, 2
    v_xor_b32 v66, s88, v66
    s_lshl_b32 s88, s65, 12
    v_lshl_add_u32 v67, v64, 7, s88
    v_lshl_add_u32 v6, v66, 4, v67
    v_xor_b32 v7, 32, v6
    v_xor_b32 v8, 64, v6
    v_xor_b32 v9, 0x60, v6
    v_bfe_u32 v68, v1, 2, 2
    v_lshlrev_b32 v69, 7, v68
    v_bfe_u32 v68, v1, 3, 1
    v_lshl_add_u32 v69, v68, 6, v69
    v_bfe_u32 v68, v1, 4, 1
    v_lshl_add_u32 v20, v68, 5, v69
    v_and_b32 v68, 3, v1
    v_lshl_add_u32 v36, v68, 3, v20
    v_lshl_add_u32 v36, v35, 10, v36
    s_mul_i32 s88, s73, 4160
    s_add_u32 s88, s88, 65536
    v_xor_b32 v10, s88, v36
    v_xor_b32 v11, 0x1000, v10
    s_mov_b32 s60, s26
    s_and_b32 s61, s27, 0xffff
    s_mov_b32 s62, 256
    s_mov_b32 s63, 0x20000
    s_or_b32 s88, s2, s64
    s_cbranch_scc1 S2_non
    s_memrealtime s[4:5]
    s_waitcnt lgkmcnt(0)
    s_mul_i32 s88, s4, 0x9e3779b1
    s_or_b32 s88, s88, 1
    v_mov_b32 v37, s88
    s_mov_b64 exec, 1
    buffer_store_dword v37, off, s[60:63], 0 sc1
    s_mov_b64 exec, -1
S2_non:
    s_xor_b32 s84, s70, 4
    s_mul_i32 s84, s84, s101
    s_xor_b32 s85, s70, 5
    s_mul_i32 s85, s85, s101
    s_mul_i32 s88, s73, 96
    s_add_u32 s88, s88, 131072
    v_xor_b32 v12, s88, v36
    v_lshlrev_b32 v16, 4, v1
    s_xor_b32 s86, s70, 6
    s_mul_i32 s86, s86, s101
    s_xor_b32 s87, s70, 7
    s_mul_i32 s87, s87, s101
    s_mov_b32 s40, s20
    s_and_b32 s41, s21, 0xffff
    s_mov_b32 s42, 0x1c0000
    s_mov_b32 s43, 0x20000
    s_mov_b32 s44, s12
    s_and_b32 s45, s13, 0xffff
    s_mov_b32 s46, 0x80000
    s_mov_b32 s47, 0x20000
    s_mov_b32 s48, s28
    s_and_b32 s49, s29, 0xffff
    s_mov_b32 s50, 0x1100000
    s_mov_b32 s51, 0x20000
    s_mov_b32 s52, s24
    s_and_b32 s53, s25, 0xffff
    s_mov_b32 s54, 0x200000
    s_mov_b32 s55, 0x20000
    s_lshl_b32 s88, s66, 2
    s_add_u32 s89, s88, s65
    s_lshl_b32 s89, s89, 2
    s_add_u32 s89, s89, s93
    s_lshl_b32 s89, s89, 1
    s_add_u32 s18, s89, s73
    s_lshl_b32 s18, s18, 7
    s_add_u32 s18, s18, 0x10a0000
    s_lshl_b32 s89, s96, 4
    s_add_u32 s19, s18, s89
    s_lshl_b32 s88, s66, 2
    s_add_u32 s88, s88, s96
    s_lshl_b32 s88, s88, 3
    s_add_u32 s88, s88, s64
    s_lshl_b32 s20, s88, 2
    s_add_u32 s20, s20, s93
    s_lshl_b32 s20, s20, 7
    s_add_u32 s20, s20, 0x10c0000
    s_lshl_b32 s21, s67, 10
    s_add_u32 s21, s21, 0x10b0000
    s_mov_b32 s97, 0x3fb8aa3b
    s_mov_b32 s100, 0x358637bd
    s_mov_b32 s75, 0xfffefffe
    s_mov_b32 s91, 0x10001
    s_mov_b32 s92, 0
    s_mov_b32 s7, 40
    v_and_b32 v32, 31, v32
    v_lshl_add_u32 v5, v32, 10, v34
    s_lshl_b32 s88, s96, 8
    s_lshl_b32 s89, s93, 17
    s_add_u32 s89, s89, s88
    v_add_u32 v13, s89, v5
    s_lshl_b32 s88, s96, 8
    s_mul_i32 s89, s93, 458752
    s_add_u32 s89, s89, s88
    v_add_u32 v5, s89, v5
    v_lshl_add_u32 v20, v35, 9, v20
    v_and_b32 v37, 1, v1
    v_lshl_add_u32 v20, v37, 4, v20
    v_bfe_u32 v37, v1, 1, 1
    v_lshl_add_u32 v20, v37, 3, v20
    s_add_u32 m0, s71, 0x8000
    s_xor_b32 s89, s72, 0x100
    buffer_load_dwordx4 v2, s[32:35], s89 offen lds
    s_cmp_eq_u32 s68, 0
    s_cbranch_scc1 QQ
WW:
    v_and_b32 v37, 31, v32
    v_lshrrev_b32 v38, 2, v33
    v_lshl_add_u32 v38, v38, 5, v37
    v_mul_lo_u32 v38, v38, s69
    v_and_b32 v37, 3, v33
    v_lshl_add_u32 v38, v37, 4, v38
    v_add_u32 v21, s79, v38
    s_xor_b32 s89, s70, s73
    s_xor_b32 s89, s89, 0
    s_add_u32 m0, s71, 0x20000
    s_mul_i32 s89, s89, 229376
    buffer_load_dwordx4 v21, s[36:39], s89 offen lds
    s_waitcnt vmcnt(5)
    s_barrier
    ds_read_b128 v[128:131], v6 offset:0
    ds_read_b64_tr_b16 v[64:65], v10 offset:0
    ds_read_b64_tr_b16 v[66:67], v10 offset:512
    ds_read_b128 v[132:135], v7 offset:0
    ds_read_b64_tr_b16 v[68:69], v10 offset:2048
    ds_read_b64_tr_b16 v[70:71], v10 offset:2560
    ds_read_b128 v[136:139], v8 offset:0
    ds_read_b64_tr_b16 v[72:73], v11 offset:0
    ds_read_b64_tr_b16 v[74:75], v11 offset:512
    ds_read_b128 v[140:143], v9 offset:0
    ds_read_b64_tr_b16 v[76:77], v11 offset:2048
    ds_read_b64_tr_b16 v[78:79], v11 offset:2560
    s_waitcnt lgkmcnt(9)
    v_mfma_f32_32x32x16_bf16 v[96:111], v[64:67], v[128:131], 0
    s_add_u32 m0, s71, 0xa000
    s_xor_b32 s89, s72, 0x10100
    buffer_load_dwordx4 v2, s[32:35], s89 offen lds
    s_waitcnt lgkmcnt(6)
    v_mfma_f32_32x32x16_bf16 v[96:111], v[68:71], v[132:135], v[96:111]
    s_add_u32 m0, s71, 0x14000
    s_nop 0
    buffer_load_dwordx4 v3, s[36:39], s82 offen lds
    s_waitcnt vmcnt(4) lgkmcnt(0)
    s_barrier
    ds_read_b128 v[144:147], v6 offset:16384
    ds_read_b64_tr_b16 v[80:81], v10 offset:8192
    ds_read_b64_tr_b16 v[82:83], v10 offset:8704
    v_mfma_f32_32x32x16_bf16 v[96:111], v[72:75], v[136:139], v[96:111]
    ds_read_b128 v[148:151], v7 offset:16384
    ds_read_b64_tr_b16 v[84:85], v10 offset:10240
    ds_read_b64_tr_b16 v[86:87], v10 offset:10752
    ds_read_b128 v[152:155], v8 offset:16384
    ds_read_b64_tr_b16 v[88:89], v11 offset:8192
    ds_read_b64_tr_b16 v[90:91], v11 offset:8704
    v_mfma_f32_32x32x16_bf16 v[96:111], v[76:79], v[140:143], v[96:111]
    ds_read_b128 v[156:159], v9 offset:16384
    ds_read_b64_tr_b16 v[92:93], v11 offset:10240
    ds_read_b64_tr_b16 v[94:95], v11 offset:10752
    s_waitcnt lgkmcnt(9)
    v_mfma_f32_32x32x16_bf16 v[96:111], v[80:83], v[144:147], v[96:111]
    s_add_u32 m0, s71, 0xc000
    s_xor_b32 s89, s72, 0x180
    buffer_load_dwordx4 v2, s[32:35], s89 offen lds
    s_add_u32 m0, s71, 0xe000
    s_xor_b32 s89, s72, 0x10180
    buffer_load_dwordx4 v2, s[32:35], s89 offen lds
    s_waitcnt lgkmcnt(6)
    v_mfma_f32_32x32x16_bf16 v[96:111], v[84:87], v[148:151], v[96:111]
    s_add_u32 m0, s71, 0x16000
    s_nop 0
    buffer_load_dwordx4 v3, s[36:39], s83 offen lds
    s_add_u32 m0, s71, 0x18000
    s_nop 0
    buffer_load_dwordx4 v4, s[36:39], s80 offen lds
    s_waitcnt vmcnt(4) lgkmcnt(0)
    s_barrier
    ds_read_b128 v[160:163], v6 offset:32768
    ds_read_b64_tr_b16 v[64:65], v10 offset:16384
    ds_read_b64_tr_b16 v[66:67], v10 offset:16896
    v_mfma_f32_32x32x16_bf16 v[96:111], v[88:91], v[152:155], v[96:111]
    v_mov_b32 v24, 0x3f80
    v_mov_b32 v25, 0
    v_mov_b32 v26, 1.0
    v_mov_b32 v27, 0
    v_mov_b32 v28, 0
    v_mov_b32 v29, 0
    v_mov_b32 v30, 0
    v_mov_b32 v31, 0
    v_mov_b32 v19, 0
    v_mov_b32 v40, 0
    v_mov_b32 v41, 0
    s_lshl_b32 s88, s73, 6
    v_lshl_add_u32 v38, v1, 1, s88
    s_lshl_b32 s88, s73, 5
    v_lshl_add_u32 v39, v1, 1, s88
    ds_read_b128 v[164:167], v7 offset:32768
    ds_read_b64_tr_b16 v[68:69], v10 offset:18432
    ds_read_b64_tr_b16 v[70:71], v10 offset:18944
    ds_read_b128 v[168:171], v8 offset:32768
    ds_read_b64_tr_b16 v[72:73], v11 offset:16384
    ds_read_b64_tr_b16 v[74:75], v11 offset:16896
    v_mfma_f32_32x32x16_bf16 v[96:111], v[92:95], v[156:159], v[96:111]
    s_mov_b32 exec_hi, 0
    buffer_load_ushort v28, v38, s[56:59], s76 offen
    buffer_load_ushort v40, v38, s[56:59], s77 offen
    buffer_load_ushort v19, v38, s[56:59], s78 offen
    s_mov_b32 exec_lo, 0xffff
    buffer_load_ushort v41, v39, s[56:59], s79 offen
    s_mov_b64 exec, -1
    ds_read_b128 v[172:175], v9 offset:32768
    ds_read_b64_tr_b16 v[76:77], v11 offset:18432
    ds_read_b64_tr_b16 v[78:79], v11 offset:18944
    ds_read_b64_tr_b16 v[80:81], v12 offset:0
    ds_read_b64_tr_b16 v[82:83], v12 offset:512
    s_waitcnt lgkmcnt(11)
    v_mfma_f32_32x32x16_bf16 v[96:111], v[64:67], v[160:163], v[96:111]
    s_add_u32 m0, s71, 0x0
    s_xor_b32 s89, s72, 0x200
    buffer_load_dwordx4 v2, s[32:35], s89 offen lds
    ds_read_b64_tr_b16 v[84:85], v12 offset:2048
    ds_read_b64_tr_b16 v[86:87], v12 offset:2560
    s_waitcnt lgkmcnt(10)
    v_mfma_f32_32x32x16_bf16 v[96:111], v[68:71], v[164:167], v[96:111]
    s_add_u32 m0, s71, 0x2000
    s_xor_b32 s89, s72, 0x10200
    buffer_load_dwordx4 v2, s[32:35], s89 offen lds
    s_waitcnt lgkmcnt(7)
    v_mfma_f32_32x32x16_bf16 v[96:111], v[72:75], v[168:171], v[96:111]
    s_add_u32 m0, s71, 0x10000
    s_nop 0
    buffer_load_dwordx4 v3, s[36:39], s84 offen lds
    s_load_dword s74, s[26:27], 0
    s_waitcnt lgkmcnt(4)
    v_mfma_f32_32x32x16_bf16 v[96:111], v[76:79], v[172:175], v[96:111]
    s_xor_b32 s89, s70, s73
    s_xor_b32 s89, s89, 2
    s_add_u32 m0, s71, 0x22000
    s_mul_i32 s89, s89, 229376
    buffer_load_dwordx4 v21, s[36:39], s89 offen lds
    s_waitcnt vmcnt(9) lgkmcnt(0)
    s_barrier
    ds_read_b128 v[176:179], v6 offset:49152
    ds_read_b64_tr_b16 v[88:89], v10 offset:24576
    ds_read_b64_tr_b16 v[90:91], v10 offset:25088
    v_mfma_f32_32x32x16_bf16 v[48:63], v[80:83], v[128:131], 0
    ds_read_b128 v[180:183], v7 offset:49152
    ds_read_b64_tr_b16 v[92:93], v10 offset:26624
    ds_read_b64_tr_b16 v[94:95], v10 offset:27136
    ds_read_b128 v[184:187], v8 offset:49152
    ds_read_b64_tr_b16 v[64:65], v11 offset:24576
    ds_read_b64_tr_b16 v[66:67], v11 offset:25088
    v_mfma_f32_32x32x16_bf16 v[48:63], v[84:87], v[132:135], v[48:63]
    ds_read_b128 v[188:191], v9 offset:49152
    ds_read_b64_tr_b16 v[68:69], v11 offset:26624
    ds_read_b64_tr_b16 v[70:71], v11 offset:27136
    ds_read_b64_tr_b16 v[72:73], v12 offset:4096
    ds_read_b64_tr_b16 v[74:75], v12 offset:4608
    s_waitcnt lgkmcnt(11)
    v_mfma_f32_32x32x16_bf16 v[96:111], v[88:91], v[176:179], v[96:111]
    s_add_u32 m0, s71, 0x4000
    s_xor_b32 s89, s72, 0x280
    buffer_load_dwordx4 v2, s[32:35], s89 offen lds
    ds_read_b64_tr_b16 v[76:77], v12 offset:6144
    ds_read_b64_tr_b16 v[78:79], v12 offset:6656
    s_waitcnt lgkmcnt(10)
    v_mfma_f32_32x32x16_bf16 v[96:111], v[92:95], v[180:183], v[96:111]
    s_add_u32 m0, s71, 0x6000
    s_xor_b32 s89, s72, 0x10280
    buffer_load_dwordx4 v2, s[32:35], s89 offen lds
    s_waitcnt lgkmcnt(7)
    v_mfma_f32_32x32x16_bf16 v[96:111], v[64:67], v[184:187], v[96:111]
    s_add_u32 m0, s71, 0x12000
    s_nop 0
    buffer_load_dwordx4 v3, s[36:39], s85 offen lds
    s_waitcnt lgkmcnt(4)
    v_mfma_f32_32x32x16_bf16 v[96:111], v[68:71], v[188:191], v[96:111]
    s_add_u32 m0, s71, 0x8000
    s_xor_b32 s89, s72, 0x300
    buffer_load_dwordx4 v2, s[32:35], s89 offen lds
    s_waitcnt vmcnt(4) lgkmcnt(0)
    s_barrier
    ds_read_b128 v[192:195], v6 offset:0
    ds_read_b64_tr_b16 v[80:81], v10 offset:0
    ds_read_b64_tr_b16 v[82:83], v10 offset:512
    v_mfma_f32_32x32x16_bf16 v[48:63], v[72:75], v[144:147], v[48:63]
    ds_read_b128 v[196:199], v7 offset:0
    ds_read_b64_tr_b16 v[84:85], v10 offset:2048
    ds_read_b64_tr_b16 v[86:87], v10 offset:2560
    ds_read_b128 v[200:203], v8 offset:0
    ds_read_b64_tr_b16 v[88:89], v11 offset:0
    ds_read_b64_tr_b16 v[90:91], v11 offset:512
    v_mfma_f32_32x32x16_bf16 v[48:63], v[76:79], v[148:151], v[48:63]
    ds_read_b128 v[204:207], v9 offset:0
    ds_read_b64_tr_b16 v[92:93], v11 offset:2048
    ds_read_b64_tr_b16 v[94:95], v11 offset:2560
    ds_read_b64_tr_b16 v[64:65], v12 offset:8192
    ds_read_b64_tr_b16 v[66:67], v12 offset:8704
    s_waitcnt lgkmcnt(11)
    v_mfma_f32_32x32x16_bf16 v[96:111], v[80:83], v[192:195], v[96:111]
    s_add_u32 m0, s71, 0xa000
    s_xor_b32 s89, s72, 0x10300
    buffer_load_dwordx4 v2, s[32:35], s89 offen lds
    ds_read_b64_tr_b16 v[68:69], v12 offset:10240
    ds_read_b64_tr_b16 v[70:71], v12 offset:10752
    s_waitcnt lgkmcnt(10)
    v_mfma_f32_32x32x16_bf16 v[96:111], v[84:87], v[196:199], v[96:111]
    s_add_u32 m0, s71, 0x14000
    s_nop 0
    buffer_load_dwordx4 v3, s[36:39], s86 offen lds
    s_waitcnt lgkmcnt(7)
    v_mfma_f32_32x32x16_bf16 v[96:111], v[88:91], v[200:203], v[96:111]
    s_xor_b32 s89, s70, s73
    s_xor_b32 s89, s89, 4
    s_add_u32 m0, s71, 0x24000
    s_mul_i32 s89, s89, 229376
    buffer_load_dwordx4 v21, s[36:39], s89 offen lds
    s_waitcnt lgkmcnt(4)
    v_mfma_f32_32x32x16_bf16 v[96:111], v[92:95], v[204:207], v[96:111]
    s_add_u32 m0, s71, 0xc000
    s_xor_b32 s89, s72, 0x380
    buffer_load_dwordx4 v2, s[32:35], s89 offen lds
    s_waitcnt vmcnt(5) lgkmcnt(0)
    s_barrier
    ds_read_b128 v[208:211], v6 offset:16384
    ds_read_b64_tr_b16 v[72:73], v10 offset:8192
    ds_read_b64_tr_b16 v[74:75], v10 offset:8704
    v_mfma_f32_32x32x16_bf16 v[48:63], v[64:67], v[160:163], v[48:63]
    ds_read_b128 v[212:215], v7 offset:16384
    ds_read_b64_tr_b16 v[76:77], v10 offset:10240
    ds_read_b64_tr_b16 v[78:79], v10 offset:10752
    ds_read_b128 v[216:219], v8 offset:16384
    ds_read_b64_tr_b16 v[80:81], v11 offset:8192
    ds_read_b64_tr_b16 v[82:83], v11 offset:8704
    v_mfma_f32_32x32x16_bf16 v[48:63], v[68:71], v[164:167], v[48:63]
    ds_read_b128 v[220:223], v9 offset:16384
    ds_read_b64_tr_b16 v[84:85], v11 offset:10240
    ds_read_b64_tr_b16 v[86:87], v11 offset:10752
    ds_read_b64_tr_b16 v[88:89], v12 offset:12288
    ds_read_b64_tr_b16 v[90:91], v12 offset:12800
    s_waitcnt lgkmcnt(11)
    v_mfma_f32_32x32x16_bf16 v[96:111], v[72:75], v[208:211], v[96:111]
    s_add_u32 m0, s71, 0xe000
    s_xor_b32 s89, s72, 0x10380
    buffer_load_dwordx4 v2, s[32:35], s89 offen lds
    s_and_b32 s88, s93, 1
    s_lshl_b32 s88, s88, 6
    s_lshl_b32 s89, s73, 5
    s_or_b32 s88, s88, s89
    v_xor_b32 v20, s88, v20
    v_lshl_or_b32 v28, v40, 16, v28
    v_lshl_or_b32 v19, v41, 16, v19
    ds_read_b64_tr_b16 v[92:93], v12 offset:14336
    ds_read_b64_tr_b16 v[94:95], v12 offset:14848
    s_waitcnt lgkmcnt(10)
    v_mfma_f32_32x32x16_bf16 v[96:111], v[76:79], v[212:215], v[96:111]
    s_add_u32 m0, s71, 0x16000
    s_nop 0
    buffer_load_dwordx4 v3, s[36:39], s87 offen lds
    s_xor_b32 s13, s94, s73
    s_lshr_b32 s88, s93, 1
    s_xor_b32 s88, s88, s13
    s_xor_b32 s88, s88, 1
    s_and_b32 s88, s88, 1
    s_lshl_b32 s10, s88, 7
    s_waitcnt lgkmcnt(7)
    v_mfma_f32_32x32x16_bf16 v[96:111], v[80:83], v[216:219], v[96:111]
    s_xor_b32 s89, s70, s73
    s_xor_b32 s89, s89, 6
    s_add_u32 m0, s71, 0x26000
    s_mul_i32 s89, s89, 229376
    buffer_load_dwordx4 v21, s[36:39], s89 offen lds
    s_waitcnt lgkmcnt(4)
    v_mfma_f32_32x32x16_bf16 v[96:111], v[84:87], v[220:223], v[96:111]
    s_add_u32 m0, s71, 0x1a000
    s_nop 0
    buffer_load_dwordx4 v4, s[36:39], s81 offen lds
    s_and_b32 s89, s94, 2
    s_lshl_b32 s89, s89, 14
    s_or_b32 s10, s10, s89
    s_lshl_b32 s89, s95, 15
    s_xor_b32 s12, s10, s89
    s_waitcnt vmcnt(5) lgkmcnt(0)
    s_barrier
    ds_read_b128 v[224:227], v6 offset:32768
    ds_read_b64_tr_b16 v[64:65], v10 offset:16384
    ds_read_b64_tr_b16 v[66:67], v10 offset:16896
    v_mfma_f32_32x32x16_bf16 v[48:63], v[88:91], v[176:179], v[48:63]
    s_lshr_b32 s88, s66, 2
    s_xor_b32 s88, s88, s65
    s_bitcmp0_b32 s88, 1
    s_cselect_b32 s89, 1, 0
    s_lshl_b32 s90, s89, 2
    s_lshr_b32 s88, s64, 1
    s_add_u32 s88, s88, s90
    s_lshl_b32 s88, s88, 7
    s_add_u32 s88, s88, s21
    v_mov_b32 v22, s18
    v_writelane_b32 v22, s20, 1
    v_writelane_b32 v22, s88, 2
    s_mov_b64 exec, 7
    buffer_load_dword v23, v22, s[48:51], 0 offen sc1
    s_mov_b64 exec, -1
    ds_read_b128 v[228:231], v7 offset:32768
    ds_read_b64_tr_b16 v[68:69], v10 offset:18432
    ds_read_b64_tr_b16 v[70:71], v10 offset:18944
    ds_read_b128 v[232:235], v8 offset:32768
    ds_read_b64_tr_b16 v[72:73], v11 offset:16384
    ds_read_b64_tr_b16 v[74:75], v11 offset:16896
    v_mfma_f32_32x32x16_bf16 v[48:63], v[92:95], v[180:183], v[48:63]
    s_lshr_b32 s88, s94, 2
    s_xor_b32 s88, s88, s95
    s_lshl_b32 s89, s88, 16
    s_or_b32 s11, s10, s89
    s_lshl_b32 s89, s88, 18
    s_or_b32 s10, s10, s89
    v_mfma_f32_32x32x16_bf16 v[96:111], v[28:31], v[24:27], v[96:111]
    ds_read_b128 v[236:239], v9 offset:32768
    ds_read_b64_tr_b16 v[76:77], v11 offset:18432
    ds_read_b64_tr_b16 v[78:79], v11 offset:18944
    ds_read_b64_tr_b16 v[80:81], v12 offset:16384
    ds_read_b64_tr_b16 v[82:83], v12 offset:16896
    s_waitcnt lgkmcnt(11)
    v_mfma_f32_32x32x16_bf16 v[96:111], v[64:67], v[224:227], v[96:111]
    s_add_u32 m0, s71, 0x1c000
    s_nop 0
    buffer_load_dwordx4 v4, s[36:39], s82 offen lds
    ds_read_b64_tr_b16 v[84:85], v12 offset:18432
    ds_read_b64_tr_b16 v[86:87], v12 offset:18944
    s_waitcnt lgkmcnt(10)
    v_mfma_f32_32x32x16_bf16 v[96:111], v[68:71], v[228:231], v[96:111]
    v_add_u32 v3, s78, v0
    s_add_u32 m0, s71, 0x0
    s_nop 0
    buffer_load_dwordx4 v3, s[36:39], s80 offen lds
    s_lshl_b32 s88, s13, 12
    s_lshl_b32 s89, s65, 10
    s_or_b32 s13, s88, s89
    s_and_b32 s14, s13, 0x3fff
    v_mfma_f32_32x32x16_bf16 v[112:127], v[28:31], v[26:29], 0
    s_waitcnt lgkmcnt(7)
    v_mfma_f32_32x32x16_bf16 v[96:111], v[72:75], v[232:235], v[96:111]
    s_add_u32 m0, s71, 0x1e000
    s_nop 0
    buffer_load_dwordx4 v4, s[36:39], s83 offen lds
    s_waitcnt lgkmcnt(4)
    v_mfma_f32_32x32x16_bf16 v[96:111], v[76:79], v[236:239], v[96:111]
    s_lshl_b32 s88, s65, 2
    s_add_u32 s88, s88, s93
    s_lshl_b32 s88, s88, 2
    s_add_u32 s88, s88, s73
    s_lshl_b32 s89, s95, 1
    s_add_u32 s8, s88, s89
    v_mov_b32 v28, v19
    s_waitcnt vmcnt(5) lgkmcnt(0)
    s_barrier
    ds_read_b128 v[240:243], v6 offset:49152
    ds_read_b64_tr_b16 v[88:89], v10 offset:24576
    ds_read_b64_tr_b16 v[90:91], v10 offset:25088
    v_mfma_f32_32x32x16_bf16 v[48:63], v[80:83], v[192:195], v[48:63]
    s_xor_b32 s9, s8, 2
    s_mul_i32 s8, s8, 10240
    s_mul_i32 s9, s9, 10240
    s_lshl_b32 s90, s66, 20
    s_add_u32 s8, s8, s90
    s_add_u32 s9, s9, s90
    ds_read_b128 v[244:247], v7 offset:49152
    ds_read_b64_tr_b16 v[92:93], v10 offset:26624
    ds_read_b64_tr_b16 v[94:95], v10 offset:27136
    ds_read_b128 v[248:251], v8 offset:49152
    ds_read_b64_tr_b16 v[64:65], v11 offset:24576
    ds_read_b64_tr_b16 v[66:67], v11 offset:25088
    v_mfma_f32_32x32x16_bf16 v[48:63], v[84:87], v[196:199], v[48:63]
    ds_read_b128 v[252:255], v9 offset:49152
    ds_read_b64_tr_b16 v[68:69], v11 offset:26624
    ds_read_b64_tr_b16 v[70:71], v11 offset:27136
    ds_read_b64_tr_b16 v[72:73], v12 offset:20480
    ds_read_b64_tr_b16 v[74:75], v12 offset:20992
    s_waitcnt lgkmcnt(11)
    v_mfma_f32_32x32x16_bf16 v[96:111], v[88:91], v[240:243], v[96:111]
    s_add_u32 m0, s71, 0x2000
    s_nop 0
    buffer_load_dwordx4 v3, s[36:39], s81 offen lds
    s_lshl_b32 s88, s96, 3
    s_add_u32 s88, s88, s64
    s_mul_i32 s88, s88, 12288
    s_lshl_b32 s89, s93, 10
    s_add_u32 s15, s88, s89
    ds_read_b64_tr_b16 v[76:77], v12 offset:22528
    ds_read_b64_tr_b16 v[78:79], v12 offset:23040
    ds_read_b64_tr_b16 v[80:81], v12 offset:24576
    ds_read_b64_tr_b16 v[82:83], v12 offset:25088
    s_waitcnt lgkmcnt(12)
    v_mfma_f32_32x32x16_bf16 v[96:111], v[92:95], v[244:247], v[96:111]
    s_add_u32 m0, s71, 0x4000
    s_nop 0
    buffer_load_dwordx4 v3, s[36:39], s82 offen lds
    v_mfma_f32_32x32x16_bf16 v[48:63], v[28:31], v[26:29], v[48:63]
    ds_read_b64_tr_b16 v[84:85], v12 offset:26624
    ds_read_b64_tr_b16 v[86:87], v12 offset:27136
    ds_read_b64_tr_b16 v[88:89], v12 offset:28672
    ds_read_b64_tr_b16 v[90:91], v12 offset:29184
    s_waitcnt lgkmcnt(13)
    v_mfma_f32_32x32x16_bf16 v[96:111], v[64:67], v[248:251], v[96:111]
    s_waitcnt lgkmcnt(0)
    s_cmp_eq_u32 s74, 0
    s_cbranch_scc1 RT_Wn
OK_Wn:
    v_and_b32 v15, 7, v1
    v_lshrrev_b32_e64 v14, v15, s74
    v_lshrrev_b32 v15, 8, v14
    v_and_b32 v14, s91, v14
    v_and_b32 v15, s91, v15
    v_mov_b32 v2, s74
    s_lshl_b32 s90, s66, 20
    s_add_u32 s15, s15, s90
    s_add_u32 s15, s15, 0xa0000
    s_lshl_b32 s17, s67, 16
    s_add_u32 s17, s17, 0x1000000
    ds_read_b64_tr_b16 v[92:93], v12 offset:30720
    ds_read_b64_tr_b16 v[94:95], v12 offset:31232
    v_mfma_f32_32x32x16_bf16 v[96:111], v[68:71], v[252:255], v[96:111]
    v_mfma_f32_32x32x16_bf16 v[48:63], v[72:75], v[208:211], v[48:63]
    s_lshl_b32 s88, s66, 2
    s_add_u32 s88, s88, s65
    s_lshl_b32 s16, s88, 15
    s_lshl_b32 s88, s96, 8
    s_add_u32 s16, s16, s88
    s_add_u32 s101, s8, 0x1000
    v_mfma_f32_32x32x16_bf16 v[48:63], v[76:79], v[212:215], v[48:63]
    s_waitcnt vmcnt(2) lgkmcnt(0)
    s_barrier
    v_add_u32 v10, 0x8000, v10
    v_add_u32 v11, 0x8000, v11
    ds_read_b64_tr_b16 v[64:65], v10 offset:0
    ds_read_b64_tr_b16 v[66:67], v10 offset:512
    v_mfma_f32_32x32x16_bf16 v[48:63], v[80:83], v[224:227], v[48:63]
    s_add_u32 m0, s71, 0x20000
    s_nop 0
    buffer_load_dwordx4 v4, s[36:39], s84 offen lds
    s_lshl_b32 s88, s93, 6
    s_add_u32 s16, s16, s88
    s_lshl_b32 s88, s73, 5
    s_add_u32 s16, s16, s88
    ds_read_b64_tr_b16 v[68:69], v10 offset:2048
    ds_read_b64_tr_b16 v[70:71], v10 offset:2560
    ds_read_b64_tr_b16 v[72:73], v11 offset:0
    ds_read_b64_tr_b16 v[74:75], v11 offset:512
    v_mfma_f32_32x32x16_bf16 v[48:63], v[84:87], v[228:231], v[48:63]
    s_add_u32 m0, s71, 0x22000
    s_nop 0
    buffer_load_dwordx4 v4, s[36:39], s85 offen lds
    ds_read_b64_tr_b16 v[76:77], v11 offset:2048
    ds_read_b64_tr_b16 v[78:79], v11 offset:2560
    ds_read_b64_tr_b16 v[80:81], v10 offset:8192
    ds_read_b64_tr_b16 v[82:83], v10 offset:8704
    v_mfma_f32_32x32x16_bf16 v[48:63], v[88:91], v[240:243], v[48:63]
    s_add_u32 m0, s71, 0x24000
    s_nop 0
    buffer_load_dwordx4 v4, s[36:39], s86 offen lds
    ds_read_b64_tr_b16 v[84:85], v10 offset:10240
    ds_read_b64_tr_b16 v[86:87], v10 offset:10752
    v_mfma_f32_32x32x16_bf16 v[48:63], v[92:95], v[244:247], v[48:63]
    s_add_u32 m0, s71, 0x26000
    s_nop 0
    buffer_load_dwordx4 v4, s[36:39], s87 offen lds
    ds_read_b64_tr_b16 v[88:89], v11 offset:8192
    ds_read_b64_tr_b16 v[90:91], v11 offset:8704
    s_waitcnt lgkmcnt(12)
    v_mfma_f32_32x32x16_bf16 v[112:127], v[64:67], v[128:131], v[112:127]
    ds_read_b64_tr_b16 v[92:93], v11 offset:10240
    ds_read_b64_tr_b16 v[94:95], v11 offset:10752
    s_waitcnt lgkmcnt(12)
    v_mfma_f32_32x32x16_bf16 v[112:127], v[68:71], v[132:135], v[112:127]
    v_mul_f32 v32, s97, v96
    v_mul_f32 v33, s97, v97
    v_mul_f32 v34, s97, v98
    v_mul_f32 v35, s97, v99
    v_mul_f32 v36, s97, v100
    v_mul_f32 v37, s97, v101
    v_mul_f32 v38, s97, v102
    v_mul_f32 v39, s97, v103
    v_exp_f32 v32, v32
    ds_read_b64_tr_b16 v[64:65], v10 offset:16384
    ds_read_b64_tr_b16 v[66:67], v10 offset:16896
    s_waitcnt lgkmcnt(12)
    v_mfma_f32_32x32x16_bf16 v[112:127], v[72:75], v[136:139], v[112:127]
    s_add_u32 m0, s71, 0x6000
    s_nop 0
    buffer_load_dwordx4 v3, s[36:39], s83 offen lds
    v_exp_f32 v33, v33
    v_exp_f32 v34, v34
    v_exp_f32 v35, v35
    v_exp_f32 v36, v36
    ds_read_b64_tr_b16 v[68:69], v10 offset:18432
    ds_read_b64_tr_b16 v[70:71], v10 offset:18944
    s_waitcnt lgkmcnt(12)
    v_mfma_f32_32x32x16_bf16 v[112:127], v[76:79], v[140:143], v[112:127]
    v_exp_f32 v37, v37
    v_exp_f32 v38, v38
    v_exp_f32 v39, v39
    v_fma_f32 v40, v32, 0.5, 1.0
    v_fma_f32 v41, v33, 0.5, 1.0
    ds_read_b64_tr_b16 v[72:73], v11 offset:16384
    ds_read_b64_tr_b16 v[74:75], v11 offset:16896
    s_waitcnt lgkmcnt(12)
    v_mfma_f32_32x32x16_bf16 v[112:127], v[80:83], v[144:147], v[112:127]
    v_fma_f32 v42, v34, 0.5, 1.0
    v_fma_f32 v43, v35, 0.5, 1.0
    v_fma_f32 v44, v36, 0.5, 1.0
    v_fma_f32 v45, v37, 0.5, 1.0
    v_fma_f32 v46, v38, 0.5, 1.0
    v_fma_f32 v47, v39, 0.5, 1.0
    v_fma_f32 v40, -v32, v40, -1.0
    v_fma_f32 v41, -v33, v41, -1.0
    v_fma_f32 v42, -v34, v42, -1.0
    ds_read_b64_tr_b16 v[76:77], v11 offset:18432
    ds_read_b64_tr_b16 v[78:79], v11 offset:18944
    s_waitcnt lgkmcnt(12)
    v_mfma_f32_32x32x16_bf16 v[112:127], v[84:87], v[148:151], v[112:127]
    v_fma_f32 v43, -v35, v43, -1.0
    v_fma_f32 v44, -v36, v44, -1.0
    v_fma_f32 v45, -v37, v45, -1.0
    v_fma_f32 v46, -v38, v46, -1.0
    v_fma_f32 v47, -v39, v47, -1.0
    v_rcp_f32 v40, v40
    v_rcp_f32 v41, v41
    ds_read_b64_tr_b16 v[80:81], v10 offset:24576
    ds_read_b64_tr_b16 v[82:83], v10 offset:25088
    s_waitcnt lgkmcnt(12)
    v_mfma_f32_32x32x16_bf16 v[112:127], v[88:91], v[152:155], v[112:127]
    s_add_u32 m0, s71, 0x8000
    s_nop 0
    buffer_load_dwordx4 v3, s[36:39], s84 offen lds
    v_rcp_f32 v42, v42
    v_rcp_f32 v43, v43
    v_rcp_f32 v44, v44
    v_rcp_f32 v45, v45
    ds_read_b64_tr_b16 v[84:85], v10 offset:26624
    ds_read_b64_tr_b16 v[86:87], v10 offset:27136
    s_waitcnt lgkmcnt(12)
    v_mfma_f32_32x32x16_bf16 v[112:127], v[92:95], v[156:159], v[112:127]
    v_rcp_f32 v46, v46
    v_rcp_f32 v47, v47
    v_fmac_f32 v96, v96, v40
    v_fmac_f32 v97, v97, v41
    v_fmac_f32 v98, v98, v42
    v_fmac_f32 v99, v99, v43
    ds_read_b64_tr_b16 v[88:89], v11 offset:24576
    ds_read_b64_tr_b16 v[90:91], v11 offset:25088
    s_waitcnt lgkmcnt(12)
    v_mfma_f32_32x32x16_bf16 v[112:127], v[64:67], v[160:163], v[112:127]
    v_fmac_f32 v100, v100, v44
    v_fmac_f32 v101, v101, v45
    v_fmac_f32 v102, v102, v46
    v_fmac_f32 v103, v103, v47
    v_cvt_pk_bf16_f32 v96, v96, v97
    v_cvt_pk_bf16_f32 v97, v98, v99
    v_cvt_pk_bf16_f32 v98, v100, v101
    v_cvt_pk_bf16_f32 v99, v102, v103
    v_and_or_b32 v96, v96, s75, v14
    ds_read_b64_tr_b16 v[92:93], v11 offset:26624
    ds_read_b64_tr_b16 v[94:95], v11 offset:27136
    s_waitcnt lgkmcnt(12)
    v_mfma_f32_32x32x16_bf16 v[112:127], v[68:71], v[164:167], v[112:127]
    v_and_or_b32 v97, v97, s75, v15
    buffer_store_dwordx4 v[96:99], v16, s[48:51], s8 offen offset:0 sc1
    v_mul_f32 v32, s97, v104
    v_mul_f32 v33, s97, v105
    v_mul_f32 v34, s97, v106
    v_mul_f32 v35, s97, v107
    v_mul_f32 v36, s97, v108
    v_mul_f32 v37, s97, v109
    s_waitcnt lgkmcnt(10)
    v_mfma_f32_32x32x16_bf16 v[112:127], v[72:75], v[168:171], v[112:127]
    s_add_u32 m0, s71, 0xa000
    s_nop 0
    buffer_load_dwordx4 v3, s[36:39], s85 offen lds
    s_and_b32 s88, s13, 0x1fff
    s_add_u32 s88, s88, 65536
    v_add_u32 v21, s88, v16
    v_xor_b32 v12, 0x1000, v21
    ds_write_b128 v12, v[56:59] offset:0
    ds_write_b128 v12, v[60:63] offset:8192
    v_mul_f32 v38, s97, v110
    v_mul_f32 v39, s97, v111
    v_xor_b32 v96, v14, v96
    v_xor_b32 v97, v15, v97
    v_exp_f32 v32, v32
    v_exp_f32 v33, v33
    v_exp_f32 v34, v34
    s_waitcnt lgkmcnt(10)
    v_mfma_f32_32x32x16_bf16 v[112:127], v[76:79], v[172:175], v[112:127]
    v_exp_f32 v35, v35
    v_exp_f32 v36, v36
    v_exp_f32 v37, v37
    v_exp_f32 v38, v38
    s_waitcnt vmcnt(4) lgkmcnt(0)
    s_barrier
    ds_read_b128 v[56:59], v21 offset:0
    ds_read_b128 v[60:63], v21 offset:8192
    ds_read_b64_tr_b16 v[64:65], v10 offset:32768
    ds_read_b64_tr_b16 v[66:67], v10 offset:33280
    v_mfma_f32_32x32x16_bf16 v[112:127], v[80:83], v[176:179], v[112:127]
    v_exp_f32 v39, v39
    v_fma_f32 v40, v32, 0.5, 1.0
    v_fma_f32 v41, v33, 0.5, 1.0
    v_fma_f32 v42, v34, 0.5, 1.0
    v_fma_f32 v43, v35, 0.5, 1.0
    v_fma_f32 v44, v36, 0.5, 1.0
    v_fma_f32 v45, v37, 0.5, 1.0
    ds_read_b64_tr_b16 v[68:69], v10 offset:34816
    ds_read_b64_tr_b16 v[70:71], v10 offset:35328
    ds_read_b64_tr_b16 v[72:73], v11 offset:32768
    ds_read_b64_tr_b16 v[74:75], v11 offset:33280
    v_mfma_f32_32x32x16_bf16 v[112:127], v[84:87], v[180:183], v[112:127]
    v_fma_f32 v46, v38, 0.5, 1.0
    v_fma_f32 v47, v39, 0.5, 1.0
    v_fma_f32 v40, -v32, v40, -1.0
    v_fma_f32 v41, -v33, v41, -1.0
    v_fma_f32 v42, -v34, v42, -1.0
    v_fma_f32 v43, -v35, v43, -1.0
    v_fma_f32 v44, -v36, v44, -1.0
    v_fma_f32 v45, -v37, v45, -1.0
    ds_read_b64_tr_b16 v[76:77], v11 offset:34816
    ds_read_b64_tr_b16 v[78:79], v11 offset:35328
    ds_read_b64_tr_b16 v[80:81], v10 offset:40960
    ds_read_b64_tr_b16 v[82:83], v10 offset:41472
    v_mfma_f32_32x32x16_bf16 v[112:127], v[88:91], v[184:187], v[112:127]
    v_fma_f32 v46, -v38, v46, -1.0
    v_fma_f32 v47, -v39, v47, -1.0
    v_rcp_f32 v40, v40
    v_rcp_f32 v41, v41
    v_rcp_f32 v42, v42
    v_rcp_f32 v43, v43
    ds_read_b64_tr_b16 v[84:85], v10 offset:43008
    ds_read_b64_tr_b16 v[86:87], v10 offset:43520
    v_mfma_f32_32x32x16_bf16 v[112:127], v[92:95], v[188:191], v[112:127]
    s_add_u32 m0, s71, 0xc000
    s_nop 0
    buffer_load_dwordx4 v3, s[36:39], s86 offen lds
    v_rcp_f32 v44, v44
    v_rcp_f32 v45, v45
    v_rcp_f32 v46, v46
    v_rcp_f32 v47, v47
    ds_read_b64_tr_b16 v[88:89], v11 offset:40960
    ds_read_b64_tr_b16 v[90:91], v11 offset:41472
    s_waitcnt lgkmcnt(12)
    v_mfma_f32_32x32x16_bf16 v[112:127], v[64:67], v[192:195], v[112:127]
    v_fmac_f32 v104, v104, v40
    v_fmac_f32 v105, v105, v41
    v_fmac_f32 v106, v106, v42
    v_fmac_f32 v107, v107, v43
    v_fmac_f32 v108, v108, v44
    v_fmac_f32 v109, v109, v45
    v_fmac_f32 v110, v110, v46
    v_fmac_f32 v111, v111, v47
    ds_read_b64_tr_b16 v[92:93], v11 offset:43008
    ds_read_b64_tr_b16 v[94:95], v11 offset:43520
    s_waitcnt lgkmcnt(12)
    v_mfma_f32_32x32x16_bf16 v[112:127], v[68:71], v[196:199], v[112:127]
    v_cvt_pk_bf16_f32 v104, v104, v105
    v_cvt_pk_bf16_f32 v105, v106, v107
    v_cvt_pk_bf16_f32 v106, v108, v109
    v_cvt_pk_bf16_f32 v107, v110, v111
    v_and_or_b32 v104, v104, s75, v14
    v_and_or_b32 v105, v105, s75, v15
    buffer_store_dwordx4 v[104:107], v16, s[48:51], s8 offen offset:1024 sc1
    s_mov_b64 exec, 1
    buffer_store_dword v2, off, s[48:51], s19 offset:0
    s_mov_b64 exec, -1
    ds_read_b64_tr_b16 v[64:65], v10 offset:49152
    ds_read_b64_tr_b16 v[66:67], v10 offset:49664
    s_waitcnt lgkmcnt(12)
    v_mfma_f32_32x32x16_bf16 v[112:127], v[72:75], v[200:203], v[112:127]
    v_add_f32 v48, v48, v56
    v_add_f32 v49, v49, v57
    v_add_f32 v50, v50, v58
    v_add_f32 v51, v51, v59
    v_add_f32 v52, v52, v60
    v_add_f32 v53, v53, v61
    ds_read_b64_tr_b16 v[68:69], v10 offset:51200
    ds_read_b64_tr_b16 v[70:71], v10 offset:51712
    s_waitcnt lgkmcnt(12)
    v_mfma_f32_32x32x16_bf16 v[112:127], v[76:79], v[204:207], v[112:127]
    s_add_u32 m0, s71, 0xe000
    s_nop 0
    buffer_load_dwordx4 v3, s[36:39], s87 offen lds
    v_add_f32 v54, v54, v62
    v_add_f32 v55, v55, v63
    v_mul_f32 v32, s97, v48
    v_mul_f32 v33, s97, v49
    v_mul_f32 v34, s97, v50
    v_mul_f32 v35, s97, v51
    v_mul_f32 v36, s97, v52
    ds_read_b64_tr_b16 v[72:73], v11 offset:49152
    ds_read_b64_tr_b16 v[74:75], v11 offset:49664
    s_waitcnt lgkmcnt(12)
    v_mfma_f32_32x32x16_bf16 v[112:127], v[80:83], v[208:211], v[112:127]
    v_mul_f32 v37, s97, v53
    v_mul_f32 v38, s97, v54
    v_mul_f32 v39, s97, v55
    v_xor_b32 v104, v14, v104
    v_xor_b32 v105, v15, v105
    v_exp_f32 v32, v32
    ds_read_b64_tr_b16 v[76:77], v11 offset:51200
    ds_read_b64_tr_b16 v[78:79], v11 offset:51712
    s_waitcnt lgkmcnt(12)
    v_mfma_f32_32x32x16_bf16 v[112:127], v[84:87], v[212:215], v[112:127]
    v_exp_f32 v33, v33
    v_exp_f32 v34, v34
    v_exp_f32 v35, v35
    v_exp_f32 v36, v36
    ds_read_b64_tr_b16 v[80:81], v10 offset:57344
    ds_read_b64_tr_b16 v[82:83], v10 offset:57856
    s_waitcnt lgkmcnt(12)
    v_mfma_f32_32x32x16_bf16 v[112:127], v[88:91], v[216:219], v[112:127]
    v_exp_f32 v37, v37
    v_exp_f32 v38, v38
    v_exp_f32 v39, v39
    ds_read_b64_tr_b16 v[84:85], v10 offset:59392
    ds_read_b64_tr_b16 v[86:87], v10 offset:59904
    s_waitcnt lgkmcnt(12)
    v_mfma_f32_32x32x16_bf16 v[112:127], v[92:95], v[220:223], v[112:127]
    v_fma_f32 v40, v32, 0.5, 1.0
    v_fma_f32 v41, v33, 0.5, 1.0
    v_fma_f32 v42, v34, 0.5, 1.0
    v_fma_f32 v43, v35, 0.5, 1.0
    v_fma_f32 v44, v36, 0.5, 1.0
    v_fma_f32 v45, v37, 0.5, 1.0
    v_fma_f32 v46, v38, 0.5, 1.0
    ds_read_b64_tr_b16 v[88:89], v11 offset:57344
    ds_read_b64_tr_b16 v[90:91], v11 offset:57856
    s_waitcnt lgkmcnt(12)
    v_mfma_f32_32x32x16_bf16 v[112:127], v[64:67], v[224:227], v[112:127]
    v_fma_f32 v47, v39, 0.5, 1.0
    v_fma_f32 v40, -v32, v40, -1.0
    v_fma_f32 v41, -v33, v41, -1.0
    v_fma_f32 v42, -v34, v42, -1.0
    v_fma_f32 v43, -v35, v43, -1.0
    v_fma_f32 v44, -v36, v44, -1.0
    v_fma_f32 v45, -v37, v45, -1.0
    ds_read_b64_tr_b16 v[92:93], v11 offset:59392
    ds_read_b64_tr_b16 v[94:95], v11 offset:59904
    s_waitcnt lgkmcnt(12)
    v_mfma_f32_32x32x16_bf16 v[112:127], v[68:71], v[228:231], v[112:127]
    v_fma_f32 v46, -v38, v46, -1.0
    v_fma_f32 v47, -v39, v47, -1.0
    v_rcp_f32 v40, v40
    v_rcp_f32 v41, v41
    v_rcp_f32 v42, v42
    s_waitcnt lgkmcnt(10)
    v_mfma_f32_32x32x16_bf16 v[112:127], v[72:75], v[232:235], v[112:127]
    v_rcp_f32 v43, v43
    v_rcp_f32 v44, v44
    v_rcp_f32 v45, v45
    s_waitcnt lgkmcnt(8)
    v_mfma_f32_32x32x16_bf16 v[112:127], v[76:79], v[236:239], v[112:127]
    v_rcp_f32 v46, v46
    v_rcp_f32 v47, v47
    v_fmac_f32 v48, v48, v40
    v_fmac_f32 v49, v49, v41
    v_fmac_f32 v50, v50, v42
    s_waitcnt vmcnt(0)
    s_barrier
    v_subrev_u32 v10, 0x18000, v10
    v_subrev_u32 v11, 0x18000, v11
    ds_read_b64_tr_b16 v[64:65], v10 offset:0
    ds_read_b64_tr_b16 v[66:67], v10 offset:512
    s_waitcnt lgkmcnt(8)
    v_mfma_f32_32x32x16_bf16 v[112:127], v[80:83], v[240:243], v[112:127]
    v_fmac_f32 v51, v51, v43
    v_fmac_f32 v52, v52, v44
    v_fmac_f32 v53, v53, v45
    v_fmac_f32 v54, v54, v46
    v_fmac_f32 v55, v55, v47
    v_cvt_pk_bf16_f32 v48, v48, v49
    v_cvt_pk_bf16_f32 v49, v50, v51
    ds_read_b64_tr_b16 v[68:69], v10 offset:2048
    ds_read_b64_tr_b16 v[70:71], v10 offset:2560
    ds_read_b64_tr_b16 v[72:73], v11 offset:0
    ds_read_b64_tr_b16 v[74:75], v11 offset:512
    s_waitcnt lgkmcnt(10)
    v_mfma_f32_32x32x16_bf16 v[112:127], v[84:87], v[244:247], v[112:127]
    v_cvt_pk_bf16_f32 v50, v52, v53
    v_cvt_pk_bf16_f32 v51, v54, v55
    v_and_or_b32 v48, v48, s75, v14
    v_and_or_b32 v49, v49, s75, v15
    buffer_store_dwordx4 v[48:51], v16, s[48:51], s101 offen offset:2048 sc1
    ds_read_b64_tr_b16 v[76:77], v11 offset:2048
    ds_read_b64_tr_b16 v[78:79], v11 offset:2560
    s_waitcnt lgkmcnt(10)
    v_mfma_f32_32x32x16_bf16 v[112:127], v[88:91], v[248:251], v[112:127]
    ds_read_b64_tr_b16 v[100:101], v10 offset:8192
    ds_read_b64_tr_b16 v[102:103], v10 offset:8704
    s_waitcnt lgkmcnt(10)
    v_mfma_f32_32x32x16_bf16 v[112:127], v[92:95], v[252:255], v[112:127]
    ds_read_b64_tr_b16 v[108:109], v10 offset:10240
    ds_read_b64_tr_b16 v[110:111], v10 offset:10752
    s_waitcnt lgkmcnt(10)
    v_mfma_f32_32x32x16_bf16 v[80:95], v[64:67], v[128:131], 0
    v_mfma_f32_32x32x16_bf16 v[80:95], v[28:31], v[24:27], v[80:95]
    s_xor_b32 m0, s13, 0x18000
    s_xor_b32 s89, s10, 0x0
    buffer_load_dwordx4 v5, s[40:43], s89 offen lds
    ds_read_b64_tr_b16 v[64:65], v11 offset:8192
    ds_read_b64_tr_b16 v[66:67], v11 offset:8704
    s_waitcnt lgkmcnt(10)
    v_mfma_f32_32x32x16_bf16 v[80:95], v[68:71], v[132:135], v[80:95]
    v_mul_f32 v32, s97, v112
    v_mul_f32 v33, s97, v113
    v_mul_f32 v34, s97, v114
    v_mul_f32 v35, s97, v115
    v_mul_f32 v36, s97, v116
    v_mul_f32 v37, s97, v117
    v_mul_f32 v38, s97, v118
    v_mul_f32 v39, s97, v119
    ds_read_b64_tr_b16 v[68:69], v11 offset:10240
    ds_read_b64_tr_b16 v[70:71], v11 offset:10752
    s_waitcnt lgkmcnt(10)
    v_mfma_f32_32x32x16_bf16 v[80:95], v[72:75], v[136:139], v[80:95]
    s_xor_b32 m0, s13, 0x1a000
    s_xor_b32 s89, s10, 0x8000
    buffer_load_dwordx4 v5, s[40:43], s89 offen lds
    v_xor_b32 v48, v14, v48
    v_xor_b32 v49, v15, v49
    v_exp_f32 v32, v32
    v_exp_f32 v33, v33
    v_exp_f32 v34, v34
    ds_read_b64_tr_b16 v[72:73], v10 offset:16384
    ds_read_b64_tr_b16 v[74:75], v10 offset:16896
    s_waitcnt lgkmcnt(10)
    v_mfma_f32_32x32x16_bf16 v[80:95], v[76:79], v[140:143], v[80:95]
    v_exp_f32 v35, v35
    v_exp_f32 v36, v36
    v_exp_f32 v37, v37
    ds_read_b64_tr_b16 v[76:77], v10 offset:18432
    ds_read_b64_tr_b16 v[78:79], v10 offset:18944
    s_waitcnt lgkmcnt(10)
    v_mfma_f32_32x32x16_bf16 v[80:95], v[100:103], v[144:147], v[80:95]
    v_exp_f32 v38, v38
    v_exp_f32 v39, v39
    v_fma_f32 v40, v32, 0.5, 1.0
    v_fma_f32 v41, v33, 0.5, 1.0
    v_fma_f32 v42, v34, 0.5, 1.0
    ds_read_b64_tr_b16 v[100:101], v11 offset:16384
    ds_read_b64_tr_b16 v[102:103], v11 offset:16896
    s_waitcnt lgkmcnt(10)
    v_mfma_f32_32x32x16_bf16 v[80:95], v[108:111], v[148:151], v[80:95]
    s_xor_b32 m0, s13, 0x1c000
    s_xor_b32 s89, s10, 0x40000
    buffer_load_dwordx4 v5, s[40:43], s89 offen lds
    v_fma_f32 v43, v35, 0.5, 1.0
    v_fma_f32 v44, v36, 0.5, 1.0
    v_fma_f32 v45, v37, 0.5, 1.0
    v_fma_f32 v46, v38, 0.5, 1.0
    v_fma_f32 v47, v39, 0.5, 1.0
    v_fma_f32 v40, -v32, v40, -1.0
    v_fma_f32 v41, -v33, v41, -1.0
    ds_read_b64_tr_b16 v[108:109], v11 offset:18432
    ds_read_b64_tr_b16 v[110:111], v11 offset:18944
    s_waitcnt lgkmcnt(10)
    v_mfma_f32_32x32x16_bf16 v[80:95], v[64:67], v[152:155], v[80:95]
    v_fma_f32 v42, -v34, v42, -1.0
    v_fma_f32 v43, -v35, v43, -1.0
    v_fma_f32 v44, -v36, v44, -1.0
    v_fma_f32 v45, -v37, v45, -1.0
    v_fma_f32 v46, -v38, v46, -1.0
    v_fma_f32 v47, -v39, v47, -1.0
    v_rcp_f32 v40, v40
    ds_read_b64_tr_b16 v[64:65], v10 offset:24576
    ds_read_b64_tr_b16 v[66:67], v10 offset:25088
    s_waitcnt lgkmcnt(10)
    v_mfma_f32_32x32x16_bf16 v[80:95], v[68:71], v[156:159], v[80:95]
    s_xor_b32 m0, s13, 0x1e000
    s_xor_b32 s89, s10, 0x48000
    buffer_load_dwordx4 v5, s[40:43], s89 offen lds
    v_rcp_f32 v41, v41
    v_rcp_f32 v42, v42
    v_rcp_f32 v43, v43
    ds_read_b64_tr_b16 v[68:69], v10 offset:26624
    ds_read_b64_tr_b16 v[70:71], v10 offset:27136
    s_waitcnt lgkmcnt(10)
    v_mfma_f32_32x32x16_bf16 v[80:95], v[72:75], v[160:163], v[80:95]
    v_rcp_f32 v44, v44
    v_rcp_f32 v45, v45
    v_rcp_f32 v46, v46
    v_rcp_f32 v47, v47
    ds_read_b64_tr_b16 v[72:73], v11 offset:24576
    ds_read_b64_tr_b16 v[74:75], v11 offset:25088
    s_waitcnt lgkmcnt(10)
    v_mfma_f32_32x32x16_bf16 v[80:95], v[76:79], v[164:167], v[80:95]
    v_fmac_f32 v112, v112, v40
    v_fmac_f32 v113, v113, v41
    v_fmac_f32 v114, v114, v42
    v_fmac_f32 v115, v115, v43
    v_fmac_f32 v116, v116, v44
    v_fmac_f32 v117, v117, v45
    ds_read_b64_tr_b16 v[76:77], v11 offset:26624
    ds_read_b64_tr_b16 v[78:79], v11 offset:27136
    s_waitcnt lgkmcnt(10)
    v_mfma_f32_32x32x16_bf16 v[80:95], v[100:103], v[168:171], v[80:95]
    s_xor_b32 m0, s13, 0x10000
    s_xor_b32 s89, s10, 0x10000
    buffer_load_dwordx4 v5, s[40:43], s89 offen lds
    v_fmac_f32 v118, v118, v46
    v_fmac_f32 v119, v119, v47
    v_cvt_pk_bf16_f32 v112, v112, v113
    v_cvt_pk_bf16_f32 v113, v114, v115
    v_cvt_pk_bf16_f32 v114, v116, v117
    v_cvt_pk_bf16_f32 v115, v118, v119
    v_and_or_b32 v112, v112, s75, v14
    ds_read_b64_tr_b16 v[100:101], v10 offset:32768
    ds_read_b64_tr_b16 v[102:103], v10 offset:33280
    s_waitcnt lgkmcnt(10)
    v_mfma_f32_32x32x16_bf16 v[80:95], v[108:111], v[172:175], v[80:95]
    v_and_or_b32 v113, v113, s75, v15
    buffer_store_dwordx4 v[112:115], v16, s[48:51], s8 offen offset:2048 sc1
    v_mul_f32 v32, s97, v120
    v_mul_f32 v33, s97, v121
    v_mul_f32 v34, s97, v122
    v_mul_f32 v35, s97, v123
    v_mul_f32 v36, s97, v124
    s_lshl_b32 s88, s95, 2
    v_xor_b32 v4, s88, v1
    v_lshl_add_u32 v4, v4, 2, s18
    s_mov_b32 s6, 1
    ds_read_b64_tr_b16 v[108:109], v10 offset:34816
    ds_read_b64_tr_b16 v[110:111], v10 offset:35328
    s_waitcnt lgkmcnt(10)
    v_mfma_f32_32x32x16_bf16 v[80:95], v[64:67], v[176:179], v[80:95]
    s_xor_b32 m0, s13, 0x12000
    s_xor_b32 s89, s10, 0x18000
    buffer_load_dwordx4 v5, s[40:43], s89 offen lds
    v_mul_f32 v37, s97, v125
    v_mul_f32 v38, s97, v126
    v_mul_f32 v39, s97, v127
    v_xor_b32 v112, v14, v112
    v_xor_b32 v113, v15, v113
    v_exp_f32 v32, v32
    buffer_load_dwordx4 v[128:131], v16, s[48:51], s9 offen offset:0 sc1
    ds_read_b64_tr_b16 v[64:65], v11 offset:32768
    ds_read_b64_tr_b16 v[66:67], v11 offset:33280
    s_waitcnt lgkmcnt(10)
    v_mfma_f32_32x32x16_bf16 v[80:95], v[68:71], v[180:183], v[80:95]
    v_exp_f32 v33, v33
    v_exp_f32 v34, v34
    v_exp_f32 v35, v35
    v_exp_f32 v36, v36
    buffer_load_dwordx4 v[132:135], v16, s[48:51], s9 offen offset:1024 sc1
    ds_read_b64_tr_b16 v[68:69], v11 offset:34816
    ds_read_b64_tr_b16 v[70:71], v11 offset:35328
    s_waitcnt lgkmcnt(10)
    v_mfma_f32_32x32x16_bf16 v[80:95], v[72:75], v[184:187], v[80:95]
    v_exp_f32 v37, v37
    v_exp_f32 v38, v38
    v_exp_f32 v39, v39
    ds_read_b64_tr_b16 v[72:73], v10 offset:40960
    ds_read_b64_tr_b16 v[74:75], v10 offset:41472
    s_waitcnt lgkmcnt(10)
    v_mfma_f32_32x32x16_bf16 v[80:95], v[76:79], v[188:191], v[80:95]
    s_xor_b32 m0, s13, 0x14000
    s_xor_b32 s89, s10, 0x50000
    buffer_load_dwordx4 v5, s[40:43], s89 offen lds
    v_fma_f32 v40, v32, 0.5, 1.0
    v_fma_f32 v41, v33, 0.5, 1.0
    v_fma_f32 v42, v34, 0.5, 1.0
    v_fma_f32 v43, v35, 0.5, 1.0
    v_fma_f32 v44, v36, 0.5, 1.0
    v_fma_f32 v45, v37, 0.5, 1.0
    v_fma_f32 v46, v38, 0.5, 1.0
    ds_read_b64_tr_b16 v[76:77], v10 offset:43008
    ds_read_b64_tr_b16 v[78:79], v10 offset:43520
    s_waitcnt lgkmcnt(10)
    v_mfma_f32_32x32x16_bf16 v[80:95], v[100:103], v[192:195], v[80:95]
    v_fma_f32 v47, v39, 0.5, 1.0
    v_fma_f32 v40, -v32, v40, -1.0
    v_fma_f32 v41, -v33, v41, -1.0
    v_fma_f32 v42, -v34, v42, -1.0
    v_fma_f32 v43, -v35, v43, -1.0
    v_fma_f32 v44, -v36, v44, -1.0
    v_fma_f32 v45, -v37, v45, -1.0
    ds_read_b64_tr_b16 v[100:101], v11 offset:40960
    ds_read_b64_tr_b16 v[102:103], v11 offset:41472
    s_waitcnt lgkmcnt(10)
    v_mfma_f32_32x32x16_bf16 v[80:95], v[108:111], v[196:199], v[80:95]
    s_xor_b32 m0, s13, 0x16000
    s_xor_b32 s89, s10, 0x58000
    buffer_load_dwordx4 v5, s[40:43], s89 offen lds
    v_fma_f32 v46, -v38, v46, -1.0
    v_fma_f32 v47, -v39, v47, -1.0
    v_rcp_f32 v40, v40
    v_rcp_f32 v41, v41
    v_rcp_f32 v42, v42
    ds_read_b64_tr_b16 v[108:109], v11 offset:43008
    ds_read_b64_tr_b16 v[110:111], v11 offset:43520
    s_waitcnt lgkmcnt(10)
    v_mfma_f32_32x32x16_bf16 v[80:95], v[64:67], v[200:203], v[80:95]
    v_rcp_f32 v43, v43
    v_rcp_f32 v44, v44
    v_rcp_f32 v45, v45
    ds_read_b64_tr_b16 v[64:65], v10 offset:49152
    ds_read_b64_tr_b16 v[66:67], v10 offset:49664
    s_waitcnt lgkmcnt(10)
    v_mfma_f32_32x32x16_bf16 v[80:95], v[68:71], v[204:207], v[80:95]
    v_rcp_f32 v46, v46
    v_rcp_f32 v47, v47
    v_fmac_f32 v120, v120, v40
    v_fmac_f32 v121, v121, v41
    v_fmac_f32 v122, v122, v42
    ds_read_b64_tr_b16 v[68:69], v10 offset:51200
    ds_read_b64_tr_b16 v[70:71], v10 offset:51712
    s_waitcnt lgkmcnt(10)
    v_mfma_f32_32x32x16_bf16 v[80:95], v[72:75], v[208:211], v[80:95]
    v_fmac_f32 v123, v123, v43
    v_fmac_f32 v124, v124, v44
    v_fmac_f32 v125, v125, v45
    v_fmac_f32 v126, v126, v46
    v_fmac_f32 v127, v127, v47
    v_cvt_pk_bf16_f32 v120, v120, v121
    v_cvt_pk_bf16_f32 v121, v122, v123
    ds_read_b64_tr_b16 v[72:73], v11 offset:49152
    ds_read_b64_tr_b16 v[74:75], v11 offset:49664
    s_waitcnt lgkmcnt(10)
    v_mfma_f32_32x32x16_bf16 v[80:95], v[76:79], v[212:215], v[80:95]
    v_cvt_pk_bf16_f32 v122, v124, v125
    v_cvt_pk_bf16_f32 v123, v126, v127
    v_and_or_b32 v120, v120, s75, v14
    v_and_or_b32 v121, v121, s75, v15
    buffer_store_dwordx4 v[120:123], v16, s[48:51], s8 offen offset:3072 sc1
    s_mov_b64 exec, 1
    buffer_store_dword v2, off, s[48:51], s19 offset:8
    s_mov_b64 exec, -1
    ds_read_b64_tr_b16 v[76:77], v11 offset:51200
    ds_read_b64_tr_b16 v[78:79], v11 offset:51712
    s_waitcnt lgkmcnt(10)
    v_mfma_f32_32x32x16_bf16 v[80:95], v[100:103], v[216:219], v[80:95]
    ds_read_b64_tr_b16 v[100:101], v10 offset:57344
    ds_read_b64_tr_b16 v[102:103], v10 offset:57856
    s_waitcnt lgkmcnt(10)
    v_mfma_f32_32x32x16_bf16 v[80:95], v[108:111], v[220:223], v[80:95]
    ds_read_b64_tr_b16 v[108:109], v10 offset:59392
    ds_read_b64_tr_b16 v[110:111], v10 offset:59904
    s_waitcnt lgkmcnt(10)
    v_mfma_f32_32x32x16_bf16 v[80:95], v[64:67], v[224:227], v[80:95]
    ds_read_b64_tr_b16 v[64:65], v11 offset:57344
    ds_read_b64_tr_b16 v[66:67], v11 offset:57856
    s_waitcnt lgkmcnt(10)
    v_mfma_f32_32x32x16_bf16 v[80:95], v[68:71], v[228:231], v[80:95]
    s_waitcnt vmcnt(5)
    v_xor_b32 v128, v14, v128
    v_xor_b32 v129, v15, v129
    v_or_b32 v17, v128, v129
    s_waitcnt vmcnt(4)
    v_xor_b32 v132, v14, v132
    ds_read_b64_tr_b16 v[68:69], v11 offset:59392
    ds_read_b64_tr_b16 v[70:71], v11 offset:59904
    s_waitcnt lgkmcnt(10)
    v_mfma_f32_32x32x16_bf16 v[80:95], v[72:75], v[232:235], v[80:95]
    v_xor_b32 v133, v15, v133
    v_or3_b32 v17, v132, v133, v17
    v_and_b32 v17, s91, v17
    v_cmp_ne_u32 vcc, 0, v17
    s_nop 0
    s_cmp_lg_u64 vcc, 0
    s_cbranch_scc1 RT_Wga
OK_Wga:
    s_waitcnt lgkmcnt(8)
    v_mfma_f32_32x32x16_bf16 v[80:95], v[76:79], v[236:239], v[80:95]
    s_waitcnt vmcnt(2) lgkmcnt(0)
    s_barrier
    s_lshl_b32 s88, s73, 13
    v_add_u32 v7, s88, v20
    v_xor_b32 v6, 64, v7
    v_add_u32 v8, 65536, v6
    v_add_u32 v9, 65536, v7
    s_lshl_b32 s88, s73, 11
    s_add_u32 s88, s88, 147456
    v_add_u32 v11, s88, v20
    v_xor_b32 v10, 64, v11
    ds_read_b64_tr_b16 v[116:117], v8 offset:32768
    ds_read_b64_tr_b16 v[118:119], v8 offset:33792
    v_mfma_f32_32x32x16_bf16 v[80:95], v[100:103], v[240:243], v[80:95]
    s_xor_b32 m0, s14, 0x24000
    s_xor_b32 s89, s12, 0x30000
    buffer_load_dwordx4 v5, s[40:43], s89 offen lds
    ds_read_b64_tr_b16 v[124:125], v9 offset:32768
    ds_read_b64_tr_b16 v[126:127], v9 offset:33792
    v_mfma_f32_32x32x16_bf16 v[80:95], v[108:111], v[244:247], v[80:95]
    s_xor_b32 m0, s14, 0x26000
    s_xor_b32 s89, s12, 0x38000
    buffer_load_dwordx4 v5, s[40:43], s89 offen lds
    ds_read_b64_tr_b16 v[72:73], v8 offset:36864
    ds_read_b64_tr_b16 v[74:75], v8 offset:37888
    v_mfma_f32_32x32x16_bf16 v[80:95], v[64:67], v[248:251], v[80:95]
    v_xor_b32 v120, v14, v120
    v_xor_b32 v121, v15, v121
    s_mov_b64 exec, 0xffff
    buffer_load_dword v0, v4, s[48:51], 0 offen sc1
    s_mov_b64 exec, -1
    ds_read_b64_tr_b16 v[76:77], v8 offset:34816
    ds_read_b64_tr_b16 v[78:79], v8 offset:35840
    v_mfma_f32_32x32x16_bf16 v[80:95], v[68:71], v[252:255], v[80:95]
    s_xor_b32 m0, s13, 0x0
    s_xor_b32 s89, s10, 0x20000
    buffer_load_dwordx4 v5, s[40:43], s89 offen lds
    ds_read_b64_tr_b16 v[108:109], v9 offset:34816
    ds_read_b64_tr_b16 v[110:111], v9 offset:35840
    s_waitcnt lgkmcnt(8)
    v_mfma_f32_32x32x16_bf16 v[192:207], v[116:119], v[96:99], 0
    ds_read_b64_tr_b16 v[64:65], v8 offset:38912
    ds_read_b64_tr_b16 v[66:67], v8 offset:39936
    s_waitcnt lgkmcnt(8)
    v_mfma_f32_32x32x16_bf16 v[208:223], v[124:127], v[96:99], 0
    s_xor_b32 m0, s13, 0x2000
    s_xor_b32 s89, s10, 0x28000
    buffer_load_dwordx4 v5, s[40:43], s89 offen lds
    v_mul_f32 v32, s97, v80
    v_mul_f32 v33, s97, v81
    v_mul_f32 v34, s97, v82
    v_mul_f32 v35, s97, v83
    v_mul_f32 v36, s97, v84
    v_mul_f32 v37, s97, v85
    v_mul_f32 v38, s97, v86
    v_mul_f32 v39, s97, v87
    v_exp_f32 v32, v32
    v_exp_f32 v33, v33
    ds_read_b64_tr_b16 v[68:69], v8 offset:0
    ds_read_b64_tr_b16 v[70:71], v8 offset:1024
    s_waitcnt lgkmcnt(8)
    v_mfma_f32_32x32x16_bf16 v[224:239], v[72:75], v[96:99], 0
    s_xor_b32 m0, s13, 0x4000
    s_xor_b32 s89, s10, 0x60000
    buffer_load_dwordx4 v5, s[40:43], s89 offen lds
    v_exp_f32 v34, v34
    v_exp_f32 v35, v35
    v_exp_f32 v36, v36
    v_exp_f32 v37, v37
    v_exp_f32 v38, v38
    v_exp_f32 v39, v39
    s_waitcnt vmcnt(3)
    v_cmp_eq_u32 vcc, s74, v0
    s_and_b32 s22, vcc_lo, 0xffff
    s_and_b32 s88, s22, 0x4000
    s_cmp_eq_u32 s88, 0x4000
    s_cbranch_scc1 ENWW1
    s_mov_b32 s23, 0x4000
    s_call_b64 s[30:31], SPIN
ENWW1:
    buffer_load_dwordx4 v[140:143], v16, s[48:51], s9 offen offset:2048 sc1
    ds_read_b64_tr_b16 v[116:117], v9 offset:0
    ds_read_b64_tr_b16 v[118:119], v9 offset:1024
    s_waitcnt lgkmcnt(8)
    v_mfma_f32_32x32x16_bf16 v[192:207], v[76:79], v[104:107], v[192:207]
    v_fma_f32 v40, v32, 0.5, 1.0
    v_fma_f32 v41, v33, 0.5, 1.0
    v_fma_f32 v42, v34, 0.5, 1.0
    v_fma_f32 v43, v35, 0.5, 1.0
    v_fma_f32 v44, v36, 0.5, 1.0
    v_fma_f32 v45, v37, 0.5, 1.0
    v_fma_f32 v46, v38, 0.5, 1.0
    v_fma_f32 v47, v39, 0.5, 1.0
    v_fma_f32 v40, -v32, v40, -1.0
    v_fma_f32 v41, -v33, v41, -1.0
    buffer_load_dwordx4 v[144:147], v16, s[48:51], s9 offen offset:3072 sc1
    ds_read_b64_tr_b16 v[124:125], v8 offset:4096
    ds_read_b64_tr_b16 v[126:127], v8 offset:5120
    s_waitcnt lgkmcnt(8)
    v_mfma_f32_32x32x16_bf16 v[208:223], v[108:111], v[104:107], v[208:223]
    s_xor_b32 m0, s13, 0x6000
    s_xor_b32 s89, s10, 0x68000
    buffer_load_dwordx4 v5, s[40:43], s89 offen lds
    v_fma_f32 v42, -v34, v42, -1.0
    v_fma_f32 v43, -v35, v43, -1.0
    v_fma_f32 v44, -v36, v44, -1.0
    v_fma_f32 v45, -v37, v45, -1.0
    v_fma_f32 v46, -v38, v46, -1.0
    v_fma_f32 v47, -v39, v47, -1.0
    v_rcp_f32 v40, v40
    v_rcp_f32 v41, v41
    v_rcp_f32 v42, v42
    s_add_u32 s90, s9, 0x1000
    buffer_load_dwordx4 v[136:139], v16, s[48:51], s90 offen offset:2048 sc1
    ds_read_b64_tr_b16 v[72:73], v8 offset:2048
    ds_read_b64_tr_b16 v[74:75], v8 offset:3072
    s_waitcnt lgkmcnt(8)
    v_mfma_f32_32x32x16_bf16 v[224:239], v[64:67], v[104:107], v[224:239]
    v_rcp_f32 v43, v43
    v_rcp_f32 v44, v44
    v_rcp_f32 v45, v45
    v_rcp_f32 v46, v46
    v_rcp_f32 v47, v47
    ds_read_b64_tr_b16 v[76:77], v9 offset:2048
    ds_read_b64_tr_b16 v[78:79], v9 offset:3072
    s_waitcnt lgkmcnt(8)
    v_mfma_f32_32x32x16_bf16 v[192:207], v[68:71], v[112:115], v[192:207]
    v_fmac_f32 v80, v80, v40
    v_fmac_f32 v81, v81, v41
    v_fmac_f32 v82, v82, v42
    v_fmac_f32 v83, v83, v43
    v_fmac_f32 v84, v84, v44
    v_fmac_f32 v85, v85, v45
    v_fmac_f32 v86, v86, v46
    v_fmac_f32 v87, v87, v47
    v_cvt_pk_bf16_f32 v80, v80, v81
    v_cvt_pk_bf16_f32 v81, v82, v83
    v_cvt_pk_bf16_f32 v82, v84, v85
    ds_read_b64_tr_b16 v[108:109], v8 offset:6144
    ds_read_b64_tr_b16 v[110:111], v8 offset:7168
    s_waitcnt lgkmcnt(8)
    v_mfma_f32_32x32x16_bf16 v[208:223], v[116:119], v[112:115], v[208:223]
    v_cvt_pk_bf16_f32 v83, v86, v87
    v_and_or_b32 v80, v80, s75, v14
    v_and_or_b32 v81, v81, s75, v15
    buffer_store_dwordx4 v[80:83], v16, s[48:51], s101 offen offset:0 sc1
    v_mul_f32 v32, s97, v88
    v_mul_f32 v33, s97, v89
    v_mul_f32 v34, s97, v90
    v_mul_f32 v35, s97, v91
    v_mul_f32 v36, s97, v92
    v_mul_f32 v37, s97, v93
    v_mul_f32 v38, s97, v94
    v_mul_f32 v39, s97, v95
    ds_read_b64_tr_b16 v[64:65], v8 offset:49152
    ds_read_b64_tr_b16 v[66:67], v8 offset:50176
    s_waitcnt lgkmcnt(8)
    v_mfma_f32_32x32x16_bf16 v[224:239], v[124:127], v[112:115], v[224:239]
    v_xor_b32 v80, v14, v80
    v_xor_b32 v81, v15, v81
    v_exp_f32 v32, v32
    v_exp_f32 v33, v33
    v_exp_f32 v34, v34
    v_exp_f32 v35, v35
    v_exp_f32 v36, v36
    ds_read_b64_tr_b16 v[68:69], v9 offset:49152
    ds_read_b64_tr_b16 v[70:71], v9 offset:50176
    s_waitcnt lgkmcnt(8)
    v_mfma_f32_32x32x16_bf16 v[192:207], v[72:75], v[120:123], v[192:207]
    v_exp_f32 v37, v37
    v_exp_f32 v38, v38
    v_exp_f32 v39, v39
    v_fma_f32 v40, v32, 0.5, 1.0
    v_fma_f32 v41, v33, 0.5, 1.0
    v_fma_f32 v42, v34, 0.5, 1.0
    v_fma_f32 v43, v35, 0.5, 1.0
    ds_read_b64_tr_b16 v[116:117], v8 offset:53248
    ds_read_b64_tr_b16 v[118:119], v8 offset:54272
    s_waitcnt lgkmcnt(8)
    v_mfma_f32_32x32x16_bf16 v[208:223], v[76:79], v[120:123], v[208:223]
    v_fma_f32 v44, v36, 0.5, 1.0
    v_fma_f32 v45, v37, 0.5, 1.0
    v_fma_f32 v46, v38, 0.5, 1.0
    v_fma_f32 v47, v39, 0.5, 1.0
    v_fma_f32 v40, -v32, v40, -1.0
    v_fma_f32 v41, -v33, v41, -1.0
    v_fma_f32 v42, -v34, v42, -1.0
    v_fma_f32 v43, -v35, v43, -1.0
    v_fma_f32 v44, -v36, v44, -1.0
    v_fma_f32 v45, -v37, v45, -1.0
    v_fma_f32 v46, -v38, v46, -1.0
    ds_read_b64_tr_b16 v[124:125], v8 offset:51200
    ds_read_b64_tr_b16 v[126:127], v8 offset:52224
    s_waitcnt lgkmcnt(8)
    v_mfma_f32_32x32x16_bf16 v[224:239], v[108:111], v[120:123], v[224:239]
    v_fma_f32 v47, -v39, v47, -1.0
    v_rcp_f32 v40, v40
    v_rcp_f32 v41, v41
    v_rcp_f32 v42, v42
    v_rcp_f32 v43, v43
    v_rcp_f32 v44, v44
    ds_read_b64_tr_b16 v[72:73], v9 offset:51200
    ds_read_b64_tr_b16 v[74:75], v9 offset:52224
    s_waitcnt lgkmcnt(8)
    v_mfma_f32_32x32x16_bf16 v[192:207], v[64:67], v[128:131], v[192:207]
    v_rcp_f32 v45, v45
    v_rcp_f32 v46, v46
    v_rcp_f32 v47, v47
    v_fmac_f32 v88, v88, v40
    v_fmac_f32 v89, v89, v41
    v_fmac_f32 v90, v90, v42
    v_fmac_f32 v91, v91, v43
    v_fmac_f32 v92, v92, v44
    ds_read_b64_tr_b16 v[76:77], v8 offset:55296
    ds_read_b64_tr_b16 v[78:79], v8 offset:56320
    s_waitcnt lgkmcnt(8)
    v_mfma_f32_32x32x16_bf16 v[208:223], v[68:71], v[128:131], v[208:223]
    v_fmac_f32 v93, v93, v45
    v_fmac_f32 v94, v94, v46
    v_fmac_f32 v95, v95, v47
    v_cvt_pk_bf16_f32 v88, v88, v89
    v_cvt_pk_bf16_f32 v89, v90, v91
    v_cvt_pk_bf16_f32 v90, v92, v93
    v_cvt_pk_bf16_f32 v91, v94, v95
    v_and_or_b32 v88, v88, s75, v14
    v_and_or_b32 v89, v89, s75, v15
    buffer_store_dwordx4 v[88:91], v16, s[48:51], s101 offen offset:1024 sc1
    ds_read_b64_tr_b16 v[108:109], v8 offset:16384
    ds_read_b64_tr_b16 v[110:111], v8 offset:17408
    s_waitcnt lgkmcnt(8)
    v_mfma_f32_32x32x16_bf16 v[224:239], v[116:119], v[128:131], v[224:239]
    ds_read_b64_tr_b16 v[64:65], v9 offset:16384
    ds_read_b64_tr_b16 v[66:67], v9 offset:17408
    s_waitcnt lgkmcnt(8)
    v_mfma_f32_32x32x16_bf16 v[192:207], v[124:127], v[132:135], v[192:207]
    s_xor_b32 m0, s13, 0x8000
    s_xor_b32 s89, s11, 0x0
    buffer_load_dwordx4 v13, s[44:47], s89 offen lds
    ds_read_b64_tr_b16 v[68:69], v8 offset:20480
    ds_read_b64_tr_b16 v[70:71], v8 offset:21504
    s_waitcnt lgkmcnt(8)
    v_mfma_f32_32x32x16_bf16 v[208:223], v[72:75], v[132:135], v[208:223]
    s_waitcnt vmcnt(6)
    v_xor_b32 v140, v14, v140
    v_xor_b32 v141, v15, v141
    v_or_b32 v17, v140, v141
    s_waitcnt vmcnt(5)
    v_xor_b32 v144, v14, v144
    v_xor_b32 v145, v15, v145
    v_or3_b32 v17, v144, v145, v17
    ds_read_b64_tr_b16 v[116:117], v8 offset:18432
    ds_read_b64_tr_b16 v[118:119], v8 offset:19456
    s_waitcnt lgkmcnt(8)
    v_mfma_f32_32x32x16_bf16 v[224:239], v[76:79], v[132:135], v[224:239]
    s_xor_b32 m0, s13, 0xa000
    s_xor_b32 s89, s11, 0x8000
    buffer_load_dwordx4 v13, s[44:47], s89 offen lds
    s_waitcnt vmcnt(4)
    v_xor_b32 v136, v14, v136
    v_xor_b32 v137, v15, v137
    v_or3_b32 v17, v136, v137, v17
    v_and_b32 v17, s91, v17
    v_cmp_ne_u32 vcc, 0, v17
    s_nop 0
    s_cmp_lg_u64 vcc, 0
    s_cbranch_scc1 RT_Wgq
OK_Wgq:
    ds_read_b64_tr_b16 v[124:125], v9 offset:18432
    ds_read_b64_tr_b16 v[126:127], v9 offset:19456
    s_waitcnt lgkmcnt(8)
    v_mfma_f32_32x32x16_bf16 v[192:207], v[108:111], v[140:143], v[192:207]
    ds_read_b64_tr_b16 v[72:73], v8 offset:22528
    ds_read_b64_tr_b16 v[74:75], v8 offset:23552
    s_waitcnt lgkmcnt(8)
    v_mfma_f32_32x32x16_bf16 v[208:223], v[64:67], v[140:143], v[208:223]
    s_xor_b32 m0, s13, 0xc000
    s_xor_b32 s89, s11, 0x10000
    buffer_load_dwordx4 v13, s[44:47], s89 offen lds
    s_barrier
    ds_read_b64_tr_b16 v[76:77], v10 offset:0
    ds_read_b64_tr_b16 v[78:79], v10 offset:1024
    s_waitcnt lgkmcnt(8)
    v_mfma_f32_32x32x16_bf16 v[224:239], v[68:71], v[140:143], v[224:239]
    ds_read_b64_tr_b16 v[108:109], v11 offset:0
    ds_read_b64_tr_b16 v[110:111], v11 offset:1024
    s_waitcnt lgkmcnt(8)
    v_mfma_f32_32x32x16_bf16 v[192:207], v[116:119], v[144:147], v[192:207]
    s_xor_b32 m0, s13, 0xe000
    s_xor_b32 s89, s11, 0x18000
    buffer_load_dwordx4 v13, s[44:47], s89 offen lds
    ds_read_b64_tr_b16 v[64:65], v10 offset:4096
    ds_read_b64_tr_b16 v[66:67], v10 offset:5120
    s_waitcnt lgkmcnt(8)
    v_mfma_f32_32x32x16_bf16 v[208:223], v[124:127], v[144:147], v[208:223]
    ds_read_b64_tr_b16 v[68:69], v10 offset:8192
    ds_read_b64_tr_b16 v[70:71], v10 offset:9216
    s_waitcnt lgkmcnt(8)
    v_mfma_f32_32x32x16_bf16 v[224:239], v[72:75], v[144:147], v[224:239]
    ds_read_b64_tr_b16 v[116:117], v11 offset:8192
    ds_read_b64_tr_b16 v[118:119], v11 offset:9216
    s_waitcnt lgkmcnt(8)
    v_mfma_f32_32x32x16_bf16 v[192:207], v[76:79], v[48:51], v[192:207]
    s_add_u32 s90, s9, 0x1000
    buffer_load_dwordx4 v[148:151], v16, s[48:51], s90 offen offset:0 sc1
    ds_read_b64_tr_b16 v[124:125], v10 offset:12288
    ds_read_b64_tr_b16 v[126:127], v10 offset:13312
    s_waitcnt lgkmcnt(8)
    v_mfma_f32_32x32x16_bf16 v[208:223], v[108:111], v[48:51], v[208:223]
    s_add_u32 s90, s9, 0x1000
    buffer_load_dwordx4 v[152:155], v16, s[48:51], s90 offen offset:1024 sc1
    s_mov_b64 exec, 0xffff
    buffer_load_dword v0, v4, s[48:51], 0 offen sc1
    s_mov_b64 exec, -1
    ds_read_b64_tr_b16 v[72:73], v6 offset:0
    ds_read_b64_tr_b16 v[74:75], v6 offset:1024
    s_waitcnt lgkmcnt(8)
    v_mfma_f32_32x32x16_bf16 v[224:239], v[64:67], v[48:51], v[224:239]
    ds_read_b64_tr_b16 v[76:77], v7 offset:0
    ds_read_b64_tr_b16 v[78:79], v7 offset:1024
    s_waitcnt lgkmcnt(8)
    v_mfma_f32_32x32x16_bf16 v[192:207], v[68:71], v[136:139], v[192:207]
    ds_read_b64_tr_b16 v[108:109], v6 offset:4096
    ds_read_b64_tr_b16 v[110:111], v6 offset:5120
    s_waitcnt lgkmcnt(8)
    v_mfma_f32_32x32x16_bf16 v[208:223], v[116:119], v[136:139], v[208:223]
    v_xor_b32 v88, v14, v88
    v_xor_b32 v89, v15, v89
    ds_read_b64_tr_b16 v[64:65], v6 offset:2048
    ds_read_b64_tr_b16 v[66:67], v6 offset:3072
    s_waitcnt lgkmcnt(8)
    v_mfma_f32_32x32x16_bf16 v[224:239], v[124:127], v[136:139], v[224:239]
    ds_read_b64_tr_b16 v[68:69], v7 offset:2048
    ds_read_b64_tr_b16 v[70:71], v7 offset:3072
    s_waitcnt lgkmcnt(8)
    v_mfma_f32_32x32x16_bf16 v[192:207], v[72:75], v[80:83], v[192:207]
    ds_read_b64_tr_b16 v[116:117], v6 offset:6144
    ds_read_b64_tr_b16 v[118:119], v6 offset:7168
    s_waitcnt lgkmcnt(8)
    v_mfma_f32_32x32x16_bf16 v[208:223], v[76:79], v[80:83], v[208:223]
    s_lshl_b32 s88, s64, 13
    v_add_u32 v12, s88, v16
    v_xor_b32 v24, 0x8000, v12
    v_and_b32 v25, 31, v1
    v_lshlrev_b32 v25, 10, v25
    v_lshrrev_b32 v3, 5, v1
    v_lshl_add_u32 v25, v3, 4, v25
    s_lshl_b32 s88, s64, 11
    s_add_u32 s88, s88, 131072
    v_add_u32 v3, s88, v16
    v_xor_b32 v26, 0x2000, v3
    v_sub_u32 v27, 3, v1
    v_lshlrev_b32 v27, 7, v27
    v_xor_b32 v27, s20, v27
    v_lshl_add_u32 v27, v1, 2, v27
    v_add_u32 v19, 65536, v12
    v_add_u32 v21, 65536, v24
    v_mov_b32 v32, 0x3f80
    s_mov_b32 vcc_lo, 0x55555555
    s_mov_b32 vcc_hi, vcc_lo
    v_cndmask_b32 v32, 1.0, v32, vcc
    s_mov_b32 vcc_lo, 0x3
    s_mov_b32 vcc_hi, 0x30
    v_cndmask_b32 v100, 0, v32, vcc
    s_mov_b32 vcc_lo, 0xc
    s_mov_b32 vcc_hi, 0xc0
    v_cndmask_b32 v101, 0, v32, vcc
    s_mov_b32 vcc_lo, 0x300
    s_mov_b32 vcc_hi, 0x3000
    v_cndmask_b32 v102, 0, v32, vcc
    s_mov_b32 vcc_lo, 0xc00
    s_mov_b32 vcc_hi, 0xc000
    v_cndmask_b32 v103, 0, v32, vcc
    s_waitcnt vmcnt(0)
    v_cmp_eq_u32 vcc, s74, v0
    s_and_b32 s22, vcc_lo, 0xffff
    s_and_b32 s88, s22, 0x11
    s_cmp_eq_u32 s88, 0x11
    s_cbranch_scc1 ENWW2
    s_mov_b32 s23, 0x11
    s_call_b64 s[30:31], SPIN
ENWW2:
    s_add_u32 s90, s8, 0x1000
    buffer_load_dwordx4 v[156:159], v16, s[48:51], s90 offen offset:3072 sc1
    ds_read_b64_tr_b16 v[124:125], v6 offset:16384
    ds_read_b64_tr_b16 v[126:127], v6 offset:17408
    s_waitcnt lgkmcnt(8)
    v_mfma_f32_32x32x16_bf16 v[224:239], v[108:111], v[80:83], v[224:239]
    s_add_u32 s90, s8, 0x2000
    buffer_load_dwordx4 v[160:163], v16, s[48:51], s90 offen offset:0 sc1
    ds_read_b64_tr_b16 v[72:73], v7 offset:16384
    ds_read_b64_tr_b16 v[74:75], v7 offset:17408
    s_waitcnt lgkmcnt(8)
    v_mfma_f32_32x32x16_bf16 v[192:207], v[64:67], v[88:91], v[192:207]
    s_add_u32 s90, s9, 0x1000
    buffer_load_dwordx4 v[164:167], v16, s[48:51], s90 offen offset:3072 sc1
    ds_read_b64_tr_b16 v[76:77], v6 offset:20480
    ds_read_b64_tr_b16 v[78:79], v6 offset:21504
    s_waitcnt lgkmcnt(8)
    v_mfma_f32_32x32x16_bf16 v[208:223], v[68:71], v[88:91], v[208:223]
    s_add_u32 s90, s9, 0x2000
    buffer_load_dwordx4 v[168:171], v16, s[48:51], s90 offen offset:0 sc1
    v_xor_b32 v148, v14, v148
    v_xor_b32 v149, v15, v149
    v_or_b32 v17, v148, v149
    v_xor_b32 v152, v14, v152
    ds_read_b64_tr_b16 v[108:109], v6 offset:18432
    ds_read_b64_tr_b16 v[110:111], v6 offset:19456
    s_waitcnt lgkmcnt(8)
    v_mfma_f32_32x32x16_bf16 v[224:239], v[116:119], v[88:91], v[224:239]
    v_xor_b32 v153, v15, v153
    v_or3_b32 v17, v152, v153, v17
    v_and_b32 v17, s91, v17
    v_cmp_ne_u32 vcc, 0, v17
    s_nop 0
    s_cmp_lg_u64 vcc, 0
    s_cbranch_scc1 RT_Wgc
OK_Wgc:
    ds_read_b64_tr_b16 v[64:65], v7 offset:18432
    ds_read_b64_tr_b16 v[66:67], v7 offset:19456
    s_waitcnt lgkmcnt(8)
    v_mfma_f32_32x32x16_bf16 v[192:207], v[124:127], v[148:151], v[192:207]
    ds_read_b64_tr_b16 v[68:69], v6 offset:22528
    ds_read_b64_tr_b16 v[70:71], v6 offset:23552
    s_waitcnt lgkmcnt(8)
    v_mfma_f32_32x32x16_bf16 v[208:223], v[72:75], v[148:151], v[208:223]
    s_barrier
    ds_read_b64_tr_b16 v[116:117], v6 offset:32768
    ds_read_b64_tr_b16 v[118:119], v6 offset:33792
    s_waitcnt lgkmcnt(8)
    v_mfma_f32_32x32x16_bf16 v[224:239], v[76:79], v[148:151], v[224:239]
    ds_read_b64_tr_b16 v[124:125], v7 offset:32768
    ds_read_b64_tr_b16 v[126:127], v7 offset:33792
    s_waitcnt lgkmcnt(8)
    v_mfma_f32_32x32x16_bf16 v[192:207], v[108:111], v[152:155], v[192:207]
    s_waitcnt vmcnt(3)
    v_xor_b32 v156, v14, v156
    v_xor_b32 v157, v15, v157
    v_or_b32 v17, v156, v157
    s_waitcnt vmcnt(2)
    v_xor_b32 v160, v14, v160
    v_xor_b32 v161, v15, v161
    ds_read_b64_tr_b16 v[72:73], v6 offset:36864
    ds_read_b64_tr_b16 v[74:75], v6 offset:37888
    s_waitcnt lgkmcnt(8)
    v_mfma_f32_32x32x16_bf16 v[208:223], v[64:67], v[152:155], v[208:223]
    v_or3_b32 v17, v160, v161, v17
    s_waitcnt vmcnt(1)
    v_xor_b32 v164, v14, v164
    v_xor_b32 v165, v15, v165
    v_or3_b32 v17, v164, v165, v17
    s_waitcnt vmcnt(0)
    ds_read_b64_tr_b16 v[76:77], v6 offset:34816
    ds_read_b64_tr_b16 v[78:79], v6 offset:35840
    s_waitcnt lgkmcnt(8)
    v_mfma_f32_32x32x16_bf16 v[224:239], v[68:71], v[152:155], v[224:239]
    v_xor_b32 v168, v14, v168
    v_xor_b32 v169, v15, v169
    v_or3_b32 v17, v168, v169, v17
    v_and_b32 v17, s91, v17
    v_cmp_ne_u32 vcc, 0, v17
    s_nop 0
    s_cmp_lg_u64 vcc, 0
    s_cbranch_scc1 RT_Wgo
OK_Wgo:
    ds_read_b64_tr_b16 v[108:109], v7 offset:34816
    ds_read_b64_tr_b16 v[110:111], v7 offset:35840
    s_waitcnt lgkmcnt(8)
    v_mfma_f32_32x32x16_bf16 v[192:207], v[116:119], v[156:159], v[192:207]
    ds_read_b64_tr_b16 v[64:65], v6 offset:38912
    ds_read_b64_tr_b16 v[66:67], v6 offset:39936
    s_waitcnt lgkmcnt(8)
    v_mfma_f32_32x32x16_bf16 v[208:223], v[124:127], v[156:159], v[208:223]
    ds_read_b64_tr_b16 v[68:69], v6 offset:49152
    ds_read_b64_tr_b16 v[70:71], v6 offset:50176
    s_waitcnt lgkmcnt(8)
    v_mfma_f32_32x32x16_bf16 v[224:239], v[72:75], v[156:159], v[224:239]
    ds_read_b64_tr_b16 v[116:117], v7 offset:49152
    ds_read_b64_tr_b16 v[118:119], v7 offset:50176
    s_waitcnt lgkmcnt(8)
    v_mfma_f32_32x32x16_bf16 v[192:207], v[76:79], v[160:163], v[192:207]
    ds_read_b64_tr_b16 v[124:125], v6 offset:53248
    ds_read_b64_tr_b16 v[126:127], v6 offset:54272
    s_waitcnt lgkmcnt(8)
    v_mfma_f32_32x32x16_bf16 v[208:223], v[108:111], v[160:163], v[208:223]
    ds_read_b64_tr_b16 v[72:73], v6 offset:51200
    ds_read_b64_tr_b16 v[74:75], v6 offset:52224
    s_waitcnt lgkmcnt(8)
    v_mfma_f32_32x32x16_bf16 v[224:239], v[64:67], v[160:163], v[224:239]
    ds_read_b64_tr_b16 v[76:77], v7 offset:51200
    ds_read_b64_tr_b16 v[78:79], v7 offset:52224
    s_waitcnt lgkmcnt(8)
    v_mfma_f32_32x32x16_bf16 v[192:207], v[68:71], v[164:167], v[192:207]
    s_add_u32 s90, s8, 0x2000
    buffer_load_dwordx4 v[172:175], v16, s[48:51], s90 offen offset:1024 sc1
    ds_read_b64_tr_b16 v[108:109], v6 offset:55296
    ds_read_b64_tr_b16 v[110:111], v6 offset:56320
    s_waitcnt lgkmcnt(8)
    v_mfma_f32_32x32x16_bf16 v[208:223], v[116:119], v[164:167], v[208:223]
    ds_read_b64_tr_b16 v[64:65], v9 offset:36864
    ds_read_b64_tr_b16 v[66:67], v9 offset:37888
    s_waitcnt lgkmcnt(8)
    v_mfma_f32_32x32x16_bf16 v[224:239], v[124:127], v[164:167], v[224:239]
    ds_read_b64_tr_b16 v[68:69], v9 offset:38912
    ds_read_b64_tr_b16 v[70:71], v9 offset:39936
    s_waitcnt lgkmcnt(8)
    v_mfma_f32_32x32x16_bf16 v[192:207], v[72:75], v[168:171], v[192:207]
    ds_read_b64_tr_b16 v[116:117], v9 offset:4096
    ds_read_b64_tr_b16 v[118:119], v9 offset:5120
    s_waitcnt lgkmcnt(8)
    v_mfma_f32_32x32x16_bf16 v[208:223], v[76:79], v[168:171], v[208:223]
    ds_read_b64_tr_b16 v[124:125], v9 offset:6144
    ds_read_b64_tr_b16 v[126:127], v9 offset:7168
    s_waitcnt lgkmcnt(8)
    v_mfma_f32_32x32x16_bf16 v[224:239], v[108:111], v[168:171], v[224:239]
    ds_read_b64_tr_b16 v[72:73], v9 offset:53248
    ds_read_b64_tr_b16 v[74:75], v9 offset:54272
    s_waitcnt lgkmcnt(8)
    v_mfma_f32_32x32x16_bf16 v[240:255], v[64:67], v[96:99], 0
    ds_write_b128 v19, v[200:203] offset:0
    ds_write_b128 v19, v[204:207] offset:1024
    s_nop 1
    ds_write_b128 v19, v[216:219] offset:2048
    ds_write_b128 v19, v[220:223] offset:3072
    s_nop 1
    ds_write_b128 v3, v[232:235] offset:0
    ds_write_b128 v3, v[236:239] offset:1024
    ds_read_b64_tr_b16 v[76:77], v9 offset:55296
    ds_read_b64_tr_b16 v[78:79], v9 offset:56320
    s_waitcnt lgkmcnt(14)
    v_mfma_f32_32x32x16_bf16 v[240:255], v[68:71], v[104:107], v[240:255]
    s_waitcnt lgkmcnt(2)
    s_barrier
    ds_read_b128 v[176:179], v21 offset:0
    ds_read_b128 v[180:183], v21 offset:1024
    ds_read_b128 v[184:187], v21 offset:2048
    ds_read_b128 v[188:191], v21 offset:3072
    ds_read_b128 v[32:35], v26 offset:0
    ds_read_b128 v[36:39], v26 offset:1024
    ds_read_b64_tr_b16 v[108:109], v9 offset:20480
    ds_read_b64_tr_b16 v[110:111], v9 offset:21504
    v_mfma_f32_32x32x16_bf16 v[240:255], v[116:119], v[112:115], v[240:255]
    s_xor_b32 s88, s15, 0xc00
    s_waitcnt lgkmcnt(6)
    v_add_f32 v176, v176, v192
    v_add_f32 v177, v177, v193
    v_add_f32 v178, v178, v194
    v_add_f32 v179, v179, v195
    v_add_f32 v180, v180, v196
    v_add_f32 v181, v181, v197
    v_add_f32 v182, v182, v198
    v_add_f32 v183, v183, v199
    v_cvt_pk_bf16_f32 v176, v176, v177
    v_cvt_pk_bf16_f32 v177, v178, v179
    v_cvt_pk_bf16_f32 v178, v180, v181
    v_cvt_pk_bf16_f32 v179, v182, v183
    v_and_or_b32 v176, v176, s75, v14
    v_and_or_b32 v177, v177, s75, v15
    buffer_store_dwordx4 v[176:179], v16, s[48:51], s88 offen offset:0 sc1
    ds_read_b64_tr_b16 v[64:65], v9 offset:22528
    ds_read_b64_tr_b16 v[66:67], v9 offset:23552
    v_mfma_f32_32x32x16_bf16 v[240:255], v[124:127], v[120:123], v[240:255]
    s_xor_b32 s88, s15, 0x800
    s_add_u32 s88, s88, 4096
    s_waitcnt lgkmcnt(6)
    v_add_f32 v184, v184, v208
    v_add_f32 v185, v185, v209
    v_add_f32 v186, v186, v210
    v_add_f32 v187, v187, v211
    v_add_f32 v188, v188, v212
    v_add_f32 v189, v189, v213
    v_add_f32 v190, v190, v214
    v_add_f32 v191, v191, v215
    v_cvt_pk_bf16_f32 v184, v184, v185
    v_cvt_pk_bf16_f32 v185, v186, v187
    v_cvt_pk_bf16_f32 v186, v188, v189
    v_cvt_pk_bf16_f32 v187, v190, v191
    v_and_or_b32 v184, v184, s75, v14
    v_and_or_b32 v185, v185, s75, v15
    buffer_store_dwordx4 v[184:187], v16, s[48:51], s88 offen offset:0 sc1
    ds_read_b64_tr_b16 v[68:69], v11 offset:4096
    ds_read_b64_tr_b16 v[70:71], v11 offset:5120
    v_mfma_f32_32x32x16_bf16 v[240:255], v[72:75], v[128:131], v[240:255]
    s_xor_b32 s88, s15, 0x400
    s_add_u32 s88, s88, 8192
    s_waitcnt lgkmcnt(6)
    v_add_f32 v32, v32, v224
    v_add_f32 v33, v33, v225
    v_add_f32 v34, v34, v226
    v_add_f32 v35, v35, v227
    v_add_f32 v36, v36, v228
    v_add_f32 v37, v37, v229
    v_add_f32 v38, v38, v230
    v_add_f32 v39, v39, v231
    v_cvt_pk_bf16_f32 v32, v32, v33
    v_cvt_pk_bf16_f32 v33, v34, v35
    v_cvt_pk_bf16_f32 v34, v36, v37
    v_cvt_pk_bf16_f32 v35, v38, v39
    v_and_or_b32 v32, v32, s75, v14
    v_and_or_b32 v33, v33, s75, v15
    buffer_store_dwordx4 v[32:35], v16, s[48:51], s88 offen offset:0 sc1
    s_mov_b64 exec, 7
    buffer_store_dword v2, v27, s[48:51], 0 offen sc1
    s_mov_b64 exec, -1
    v_lshl_add_u32 v4, v1, 2, s20
    s_mov_b32 s6, 0
    ds_read_b64_tr_b16 v[116:117], v11 offset:12288
    ds_read_b64_tr_b16 v[118:119], v11 offset:13312
    v_mfma_f32_32x32x16_bf16 v[240:255], v[76:79], v[132:135], v[240:255]
    ds_read_b64_tr_b16 v[124:125], v7 offset:4096
    ds_read_b64_tr_b16 v[126:127], v7 offset:5120
    s_waitcnt lgkmcnt(8)
    v_mfma_f32_32x32x16_bf16 v[240:255], v[108:111], v[140:143], v[240:255]
    ds_read_b64_tr_b16 v[72:73], v7 offset:6144
    ds_read_b64_tr_b16 v[74:75], v7 offset:7168
    s_waitcnt lgkmcnt(8)
    v_mfma_f32_32x32x16_bf16 v[240:255], v[64:67], v[144:147], v[240:255]
    ds_read_b64_tr_b16 v[76:77], v7 offset:20480
    ds_read_b64_tr_b16 v[78:79], v7 offset:21504
    s_waitcnt lgkmcnt(8)
    v_mfma_f32_32x32x16_bf16 v[240:255], v[68:71], v[48:51], v[240:255]
    ds_read_b64_tr_b16 v[108:109], v7 offset:22528
    ds_read_b64_tr_b16 v[110:111], v7 offset:23552
    s_waitcnt lgkmcnt(8)
    v_mfma_f32_32x32x16_bf16 v[240:255], v[116:119], v[136:139], v[240:255]
    ds_read_b64_tr_b16 v[64:65], v7 offset:36864
    ds_read_b64_tr_b16 v[66:67], v7 offset:37888
    s_waitcnt lgkmcnt(8)
    v_mfma_f32_32x32x16_bf16 v[240:255], v[124:127], v[80:83], v[240:255]
    ds_read_b64_tr_b16 v[68:69], v7 offset:38912
    ds_read_b64_tr_b16 v[70:71], v7 offset:39936
    s_waitcnt lgkmcnt(8)
    v_mfma_f32_32x32x16_bf16 v[240:255], v[72:75], v[88:91], v[240:255]
    ds_read_b64_tr_b16 v[116:117], v7 offset:53248
    ds_read_b64_tr_b16 v[118:119], v7 offset:54272
    s_waitcnt lgkmcnt(8)
    v_mfma_f32_32x32x16_bf16 v[240:255], v[76:79], v[148:151], v[240:255]
    ds_read_b64_tr_b16 v[124:125], v7 offset:55296
    ds_read_b64_tr_b16 v[126:127], v7 offset:56320
    s_waitcnt lgkmcnt(8)
    v_mfma_f32_32x32x16_bf16 v[240:255], v[108:111], v[152:155], v[240:255]
    s_waitcnt lgkmcnt(6)
    v_mfma_f32_32x32x16_bf16 v[240:255], v[64:67], v[156:159], v[240:255]
    s_waitcnt lgkmcnt(4)
    v_mfma_f32_32x32x16_bf16 v[240:255], v[68:71], v[160:163], v[240:255]
    s_waitcnt vmcnt(4)
    v_xor_b32 v172, v14, v172
    v_xor_b32 v173, v15, v173
    v_or_b32 v17, v172, v173
    v_and_b32 v17, s91, v17
    v_cmp_ne_u32 vcc, 0, v17
    s_nop 0
    s_cmp_lg_u64 vcc, 0
    s_cbranch_scc1 RT_Wgp
OK_Wgp:
    s_waitcnt lgkmcnt(2)
    v_mfma_f32_32x32x16_bf16 v[240:255], v[116:119], v[164:167], v[240:255]
    s_waitcnt lgkmcnt(0)
    v_mfma_f32_32x32x16_bf16 v[240:255], v[124:127], v[168:171], v[240:255]
    s_mov_b64 exec, 0xffff
    buffer_load_dword v0, v4, s[48:51], 0 offen sc1
    s_mov_b64 exec, -1
    s_nop 8
    ds_write_b128 v12, v[248:251] offset:0
    ds_write_b128 v12, v[252:255] offset:1024
    s_waitcnt lgkmcnt(0)
    s_barrier
    ds_read_b128 v[40:43], v24 offset:0
    ds_read_b128 v[44:47], v24 offset:1024
    s_waitcnt vmcnt(0)
    v_cmp_eq_u32 vcc, s74, v0
    s_and_b32 s22, vcc_lo, 0xffff
    s_and_b32 s88, s22, 0x7
    s_cmp_eq_u32 s88, 0x7
    s_cbranch_scc1 ENWW3
    s_mov_b32 s23, 0x7
    s_call_b64 s[30:31], SPIN
ENWW3:
    buffer_load_dwordx4 v[52:55], v16, s[48:51], s15 offen offset:0 sc1
    s_add_u32 s90, s15, 0x1000
    buffer_load_dwordx4 v[56:59], v16, s[48:51], s90 offen offset:0 sc1
    s_add_u32 s90, s15, 0x2000
    buffer_load_dwordx4 v[60:63], v16, s[48:51], s90 offen offset:0 sc1
    s_waitcnt lgkmcnt(0)
    v_mul_f32 v40, v174, v40
    v_mul_f32 v41, v174, v41
    v_mul_f32 v42, v174, v42
    v_mul_f32 v43, v174, v43
    v_mul_f32 v44, v174, v44
    v_mul_f32 v45, v174, v45
    v_mul_f32 v46, v174, v46
    v_mul_f32 v47, v174, v47
    s_waitcnt vmcnt(2)
    v_xor_b32 v52, v14, v52
    v_xor_b32 v53, v15, v53
    v_or_b32 v17, v52, v53
    s_nop 0
    v_mfma_f32_32x32x16_bf16 v[192:207], v[100:103], v[52:55], v[240:255]
    s_waitcnt vmcnt(1)
    v_xor_b32 v56, v14, v56
    v_xor_b32 v57, v15, v57
    v_or3_b32 v17, v56, v57, v17
    s_nop 0
    v_mfma_f32_32x32x16_bf16 v[192:207], v[100:103], v[56:59], v[192:207]
    s_waitcnt vmcnt(0)
    v_xor_b32 v60, v14, v60
    v_xor_b32 v61, v15, v61
    v_or3_b32 v17, v60, v61, v17
    s_nop 0
    v_mfma_f32_32x32x16_bf16 v[192:207], v[100:103], v[60:63], v[192:207]
    v_and_b32 v17, s91, v17
    v_cmp_ne_u32 vcc, 0, v17
    s_nop 0
    s_cmp_lg_u64 vcc, 0
    s_cbranch_scc1 RT_Wpr
OK_Wpr:
    s_nop 6
    v_fmac_f32 v40, v174, v192
    v_fmac_f32 v41, v174, v193
    v_fmac_f32 v42, v174, v194
    v_fmac_f32 v43, v174, v195
    v_fmac_f32 v44, v174, v196
    v_fmac_f32 v45, v174, v197
    v_fmac_f32 v46, v174, v198
    v_fmac_f32 v47, v174, v199
    v_cvt_pk_bf16_f32 v40, v40, v41
    v_cvt_pk_bf16_f32 v41, v42, v43
    v_cvt_pk_bf16_f32 v42, v44, v45
    v_cvt_pk_bf16_f32 v43, v46, v47
    buffer_store_dwordx4 v[40:43], v25, s[52:55], s16 offen
END:
    s_endpgm
.p2align 3
SPIN:
    s_mov_b64 exec, 0xffff
SPIN_loop:
    buffer_load_dword v0, v4, s[48:51], 0 offen sc1
    s_waitcnt vmcnt(0)
    v_cmp_eq_u32 vcc, s74, v0
    s_add_u32 s92, s92, 1
    s_mov_b32 s22, vcc_lo
    s_and_b32 s88, s22, s23
    s_cmp_eq_u32 s88, s23
    s_cbranch_scc1 SPIN_done
    s_sleep 1
    s_sub_u32 s7, s7, s6
    s_cmp_lt_i32 s7, 0
    s_cbranch_scc1 SPIN_done
    s_cmp_lt_u32 s92, 0x4e20
    s_cbranch_scc1 SPIN_loop
SPIN_done:
    s_mov_b64 exec, -1
    s_setpc_b64 s[30:31]
.p2align 3
QQ:
    v_lshlrev_b32 v16, 4, v1
    s_lshl_b32 s88, s70, 7
    v_xor_b32 v21, s88, v16
    s_add_u32 m0, s71, 0x26000
    s_lshl_b32 s88, s73, 6
    s_add_u32 s88, s88, m0
    v_lshrrev_b32 v12, 2, v1
    v_xor_b32 v12, s73, v12
    v_and_b32 v12, 1, v12
    v_lshl_or_b32 v21, v12, 10, v21
    buffer_load_dwordx4 v21, s[56:59], 0 offen lds
    v_lshl_add_u32 v12, v35, 4, s88
    s_mov_b32 s4, 0x10100101
    s_mov_b32 s5, s4
    v_xor_b32 v21, 64, v12
    v_cndmask_b32_e64 v12, v21, v12, s[4:5]
    s_waitcnt vmcnt(5)
    s_barrier
    ds_read_b128 v[128:131], v6 offset:0
    ds_read_b64_tr_b16 v[64:65], v10 offset:0
    ds_read_b64_tr_b16 v[66:67], v10 offset:512
    ds_read_b128 v[132:135], v7 offset:0
    ds_read_b64_tr_b16 v[68:69], v10 offset:2048
    ds_read_b64_tr_b16 v[70:71], v10 offset:2560
    ds_read_b128 v[136:139], v8 offset:0
    ds_read_b64_tr_b16 v[72:73], v11 offset:0
    ds_read_b64_tr_b16 v[74:75], v11 offset:512
    ds_read_b128 v[140:143], v9 offset:0
    ds_read_b64_tr_b16 v[76:77], v11 offset:2048
    ds_read_b64_tr_b16 v[78:79], v11 offset:2560
    s_waitcnt lgkmcnt(9)
    v_mfma_f32_32x32x16_bf16 v[96:111], v[128:131], v[64:67], 0
    s_add_u32 m0, s71, 0xa000
    s_xor_b32 s89, s72, 0x10100
    buffer_load_dwordx4 v2, s[32:35], s89 offen lds
    s_waitcnt lgkmcnt(6)
    v_mfma_f32_32x32x16_bf16 v[96:111], v[132:135], v[68:71], v[96:111]
    s_add_u32 m0, s71, 0x14000
    s_nop 0
    buffer_load_dwordx4 v3, s[36:39], s82 offen lds
    s_waitcnt vmcnt(4) lgkmcnt(0)
    s_barrier
    ds_read_b128 v[144:147], v6 offset:16384
    ds_read_b64_tr_b16 v[80:81], v10 offset:8192
    ds_read_b64_tr_b16 v[82:83], v10 offset:8704
    v_mfma_f32_32x32x16_bf16 v[96:111], v[136:139], v[72:75], v[96:111]
    s_lshl_b32 s88, s64, 11
    s_add_u32 s88, s88, 65536
    v_add_u32 v24, s88, v16
    s_lshr_b32 s88, s65, 1
    s_lshl_b32 s88, s88, 13
    s_and_b32 s89, s65, 1
    s_lshl_b32 s89, s89, 8
    s_add_u32 s88, s88, s89
    s_add_u32 s88, s88, 65536
    v_and_b32 v25, 0x300, v16
    v_add3_u32 v25, v25, v16, s88
    ds_read_b128 v[148:151], v7 offset:16384
    ds_read_b64_tr_b16 v[84:85], v10 offset:10240
    ds_read_b64_tr_b16 v[86:87], v10 offset:10752
    ds_read_b128 v[152:155], v8 offset:16384
    ds_read_b64_tr_b16 v[88:89], v11 offset:8192
    ds_read_b64_tr_b16 v[90:91], v11 offset:8704
    v_mfma_f32_32x32x16_bf16 v[96:111], v[140:143], v[76:79], v[96:111]
    ds_read_b128 v[156:159], v9 offset:16384
    ds_read_b64_tr_b16 v[92:93], v11 offset:10240
    ds_read_b64_tr_b16 v[94:95], v11 offset:10752
    s_waitcnt lgkmcnt(9)
    v_mfma_f32_32x32x16_bf16 v[96:111], v[144:147], v[80:83], v[96:111]
    s_add_u32 m0, s71, 0xc000
    s_xor_b32 s89, s72, 0x180
    buffer_load_dwordx4 v2, s[32:35], s89 offen lds
    s_add_u32 m0, s71, 0xe000
    s_xor_b32 s89, s72, 0x10180
    buffer_load_dwordx4 v2, s[32:35], s89 offen lds
    v_mov_b32 v60, 0x3f803f80
    v_mov_b32 v61, 0x3f803f80
    v_mov_b32 v62, 0x3f803f80
    v_mov_b32 v63, 0x3f803f80
    s_waitcnt lgkmcnt(6)
    v_mfma_f32_32x32x16_bf16 v[96:111], v[148:151], v[84:87], v[96:111]
    s_add_u32 m0, s71, 0x16000
    s_nop 0
    buffer_load_dwordx4 v3, s[36:39], s83 offen lds
    s_add_u32 m0, s71, 0x18000
    s_nop 0
    buffer_load_dwordx4 v4, s[36:39], s80 offen lds
    s_waitcnt vmcnt(4) lgkmcnt(0)
    s_barrier
    ds_read_b128 v[160:163], v6 offset:32768
    ds_read_b64_tr_b16 v[64:65], v10 offset:16384
    ds_read_b64_tr_b16 v[66:67], v10 offset:16896
    v_mfma_f32_32x32x16_bf16 v[96:111], v[152:155], v[88:91], v[96:111]
    ds_read_b128 v[164:167], v7 offset:32768
    ds_read_b64_tr_b16 v[68:69], v10 offset:18432
    ds_read_b64_tr_b16 v[70:71], v10 offset:18944
    ds_read_b128 v[168:171], v8 offset:32768
    ds_read_b64_tr_b16 v[72:73], v11 offset:16384
    ds_read_b64_tr_b16 v[74:75], v11 offset:16896
    v_mfma_f32_32x32x16_bf16 v[96:111], v[156:159], v[92:95], v[96:111]
    ds_read_b128 v[172:175], v9 offset:32768
    ds_read_b64_tr_b16 v[76:77], v11 offset:18432
    ds_read_b64_tr_b16 v[78:79], v11 offset:18944
    ds_read_b128 v[80:83], v12 offset:0
    s_waitcnt lgkmcnt(10)
    v_mfma_f32_32x32x16_bf16 v[96:111], v[160:163], v[64:67], v[96:111]
    s_add_u32 m0, s71, 0x0
    s_xor_b32 s89, s72, 0x200
    buffer_load_dwordx4 v2, s[32:35], s89 offen lds
    ds_read_b128 v[84:87], v12 offset:32
    s_waitcnt lgkmcnt(8)
    v_mfma_f32_32x32x16_bf16 v[96:111], v[164:167], v[68:71], v[96:111]
    s_add_u32 m0, s71, 0x2000
    s_xor_b32 s89, s72, 0x10200
    buffer_load_dwordx4 v2, s[32:35], s89 offen lds
    s_waitcnt lgkmcnt(5)
    v_mfma_f32_32x32x16_bf16 v[96:111], v[168:171], v[72:75], v[96:111]
    s_add_u32 m0, s71, 0x10000
    s_nop 0
    buffer_load_dwordx4 v3, s[36:39], s84 offen lds
    s_load_dword s74, s[26:27], 0
    s_waitcnt lgkmcnt(2)
    v_mfma_f32_32x32x16_bf16 v[96:111], v[172:175], v[76:79], v[96:111]
    s_add_u32 m0, s71, 0x4000
    s_xor_b32 s89, s72, 0x280
    buffer_load_dwordx4 v2, s[32:35], s89 offen lds
    s_waitcnt vmcnt(5) lgkmcnt(0)
    s_barrier
    ds_read_b128 v[176:179], v6 offset:49152
    ds_read_b64_tr_b16 v[88:89], v10 offset:24576
    ds_read_b64_tr_b16 v[90:91], v10 offset:25088
    v_mfma_f32_16x16x32_bf16 v[48:51], v[80:83], v[128:131], 0
    ds_read_b128 v[180:183], v7 offset:49152
    ds_read_b64_tr_b16 v[92:93], v10 offset:26624
    ds_read_b64_tr_b16 v[94:95], v10 offset:27136
    ds_read_b128 v[184:187], v8 offset:49152
    ds_read_b64_tr_b16 v[64:65], v11 offset:24576
    ds_read_b64_tr_b16 v[66:67], v11 offset:25088
    v_mfma_f32_16x16x32_bf16 v[48:51], v[84:87], v[132:135], v[48:51]
    ds_read_b128 v[188:191], v9 offset:49152
    ds_read_b64_tr_b16 v[68:69], v11 offset:26624
    ds_read_b64_tr_b16 v[70:71], v11 offset:27136
    ds_read_b128 v[72:75], v12 offset:128
    s_waitcnt lgkmcnt(10)
    v_mfma_f32_32x32x16_bf16 v[96:111], v[176:179], v[88:91], v[96:111]
    s_add_u32 m0, s71, 0x6000
    s_xor_b32 s89, s72, 0x10280
    buffer_load_dwordx4 v2, s[32:35], s89 offen lds
    v_mov_b32 v52, 0x3f80
    s_mov_b32 vcc_lo, 0x55555555
    s_mov_b32 vcc_hi, vcc_lo
    v_cndmask_b32 v52, 1.0, v52, vcc
    ds_read_b128 v[76:79], v12 offset:160
    s_waitcnt lgkmcnt(8)
    v_mfma_f32_32x32x16_bf16 v[96:111], v[180:183], v[92:95], v[96:111]
    s_add_u32 m0, s71, 0x12000
    s_nop 0
    buffer_load_dwordx4 v3, s[36:39], s85 offen lds
    s_mov_b32 vcc_lo, 0x3000003
    s_mov_b32 vcc_hi, 0x3000003
    v_cndmask_b32 v56, 0, v52, vcc
    s_waitcnt lgkmcnt(5)
    v_mfma_f32_32x32x16_bf16 v[96:111], v[184:187], v[64:67], v[96:111]
    s_add_u32 m0, s71, 0x8000
    s_xor_b32 s89, s72, 0x300
    buffer_load_dwordx4 v2, s[32:35], s89 offen lds
    s_mov_b32 vcc_lo, 0xc00000c
    s_mov_b32 vcc_hi, 0xc00000c
    v_cndmask_b32 v57, 0, v52, vcc
    s_waitcnt lgkmcnt(2)
    v_mfma_f32_32x32x16_bf16 v[96:111], v[188:191], v[68:71], v[96:111]
    s_add_u32 m0, s71, 0xa000
    s_xor_b32 s89, s72, 0x10300
    buffer_load_dwordx4 v2, s[32:35], s89 offen lds
    s_mov_b32 vcc_lo, 0x30000030
    s_mov_b32 vcc_hi, 0x30000030
    v_cndmask_b32 v58, 0, v52, vcc
    s_waitcnt vmcnt(5) lgkmcnt(0)
    s_barrier
    ds_read_b128 v[192:195], v6 offset:0
    ds_read_b64_tr_b16 v[80:81], v10 offset:0
    ds_read_b64_tr_b16 v[82:83], v10 offset:512
    v_mfma_f32_16x16x32_bf16 v[48:51], v[72:75], v[144:147], v[48:51]
    s_mov_b32 vcc_lo, 0xc00000c0
    s_mov_b32 vcc_hi, 0xc00000c0
    v_cndmask_b32 v59, 0, v52, vcc
    ds_read_b128 v[196:199], v7 offset:0
    ds_read_b64_tr_b16 v[84:85], v10 offset:2048
    ds_read_b64_tr_b16 v[86:87], v10 offset:2560
    ds_read_b128 v[200:203], v8 offset:0
    ds_read_b64_tr_b16 v[88:89], v11 offset:0
    ds_read_b64_tr_b16 v[90:91], v11 offset:512
    v_mfma_f32_16x16x32_bf16 v[48:51], v[76:79], v[148:151], v[48:51]
    s_mov_b32 vcc_lo, 0x3
    s_mov_b32 vcc_hi, 0x30
    v_cndmask_b32 v28, 0, v52, vcc
    ds_read_b128 v[204:207], v9 offset:0
    ds_read_b64_tr_b16 v[92:93], v11 offset:2048
    ds_read_b64_tr_b16 v[94:95], v11 offset:2560
    ds_read_b128 v[64:67], v12 offset:256
    s_waitcnt lgkmcnt(10)
    v_mfma_f32_32x32x16_bf16 v[96:111], v[192:195], v[80:83], v[96:111]
    s_add_u32 m0, s71, 0x14000
    s_nop 0
    buffer_load_dwordx4 v3, s[36:39], s86 offen lds
    s_mov_b32 vcc_lo, 0xc
    s_mov_b32 vcc_hi, 0xc0
    v_cndmask_b32 v29, 0, v52, vcc
    ds_read_b128 v[68:71], v12 offset:288
    s_waitcnt lgkmcnt(8)
    v_mfma_f32_32x32x16_bf16 v[96:111], v[196:199], v[84:87], v[96:111]
    s_add_u32 m0, s71, 0xc000
    s_xor_b32 s89, s72, 0x380
    buffer_load_dwordx4 v2, s[32:35], s89 offen lds
    s_mov_b32 vcc_lo, 0x300
    s_mov_b32 vcc_hi, 0x3000
    v_cndmask_b32 v30, 0, v52, vcc
    s_waitcnt lgkmcnt(5)
    v_mfma_f32_32x32x16_bf16 v[96:111], v[200:203], v[88:91], v[96:111]
    s_add_u32 m0, s71, 0xe000
    s_xor_b32 s89, s72, 0x10380
    buffer_load_dwordx4 v2, s[32:35], s89 offen lds
    s_mov_b32 vcc_lo, 0xc00
    s_mov_b32 vcc_hi, 0xc000
    v_cndmask_b32 v31, 0, v52, vcc
    s_waitcnt lgkmcnt(2)
    v_mfma_f32_32x32x16_bf16 v[96:111], v[204:207], v[92:95], v[96:111]
    s_add_u32 m0, s71, 0x16000
    s_nop 0
    buffer_load_dwordx4 v3, s[36:39], s87 offen lds
    s_waitcnt vmcnt(6) lgkmcnt(0)
    s_barrier
    ds_read_b128 v[208:211], v6 offset:16384
    ds_read_b64_tr_b16 v[72:73], v10 offset:8192
    ds_read_b64_tr_b16 v[74:75], v10 offset:8704
    v_mfma_f32_16x16x32_bf16 v[48:51], v[64:67], v[160:163], v[48:51]
    ds_read_b128 v[212:215], v7 offset:16384
    ds_read_b64_tr_b16 v[76:77], v10 offset:10240
    ds_read_b64_tr_b16 v[78:79], v10 offset:10752
    ds_read_b128 v[216:219], v8 offset:16384
    ds_read_b64_tr_b16 v[80:81], v11 offset:8192
    ds_read_b64_tr_b16 v[82:83], v11 offset:8704
    v_mfma_f32_16x16x32_bf16 v[48:51], v[68:71], v[164:167], v[48:51]
    ds_read_b128 v[220:223], v9 offset:16384
    ds_read_b64_tr_b16 v[84:85], v11 offset:10240
    ds_read_b64_tr_b16 v[86:87], v11 offset:10752
    ds_read_b128 v[88:91], v12 offset:384
    s_waitcnt lgkmcnt(10)
    v_mfma_f32_32x32x16_bf16 v[96:111], v[208:211], v[72:75], v[96:111]
    s_add_u32 m0, s71, 0x1a000
    s_nop 0
    buffer_load_dwordx4 v4, s[36:39], s81 offen lds
    s_and_b32 s88, s93, 1
    s_lshl_b32 s88, s88, 6
    s_lshl_b32 s89, s73, 5
    s_or_b32 s88, s88, s89
    v_xor_b32 v20, s88, v20
    ds_read_b128 v[92:95], v12 offset:416
    s_waitcnt lgkmcnt(8)
    v_mfma_f32_32x32x16_bf16 v[96:111], v[212:215], v[76:79], v[96:111]
    s_add_u32 m0, s71, 0x1c000
    s_nop 0
    buffer_load_dwordx4 v4, s[36:39], s82 offen lds
    s_xor_b32 s13, s94, s73
    s_lshr_b32 s88, s93, 1
    s_xor_b32 s88, s88, s13
    s_xor_b32 s88, s88, 1
    s_and_b32 s88, s88, 1
    s_lshl_b32 s10, s88, 7
    s_waitcnt lgkmcnt(5)
    v_mfma_f32_32x32x16_bf16 v[96:111], v[216:219], v[80:83], v[96:111]
    v_add_u32 v3, s78, v0
    s_add_u32 m0, s71, 0x0
    s_nop 0
    buffer_load_dwordx4 v3, s[36:39], s80 offen lds
    s_waitcnt lgkmcnt(2)
    v_mfma_f32_32x32x16_bf16 v[96:111], v[220:223], v[84:87], v[96:111]
    s_and_b32 s89, s94, 2
    s_lshl_b32 s89, s89, 14
    s_or_b32 s10, s10, s89
    s_lshl_b32 s89, s95, 15
    s_xor_b32 s12, s10, s89
    s_waitcnt vmcnt(6) lgkmcnt(0)
    s_barrier
    ds_read_b128 v[224:227], v6 offset:32768
    ds_read_b64_tr_b16 v[64:65], v10 offset:16384
    ds_read_b64_tr_b16 v[66:67], v10 offset:16896
    v_mfma_f32_16x16x32_bf16 v[48:51], v[88:91], v[176:179], v[48:51]
    s_lshr_b32 s88, s66, 2
    s_xor_b32 s88, s88, s65
    s_bitcmp0_b32 s88, 1
    s_cselect_b32 s89, 1, 0
    s_lshl_b32 s90, s89, 2
    s_lshr_b32 s88, s64, 1
    s_add_u32 s88, s88, s90
    s_lshl_b32 s88, s88, 7
    s_add_u32 s88, s88, s21
    v_mov_b32 v22, s18
    v_writelane_b32 v22, s20, 1
    v_writelane_b32 v22, s88, 2
    s_mov_b64 exec, 7
    buffer_load_dword v23, v22, s[48:51], 0 offen sc1
    s_mov_b64 exec, -1
    ds_read_b128 v[228:231], v7 offset:32768
    ds_read_b64_tr_b16 v[68:69], v10 offset:18432
    ds_read_b64_tr_b16 v[70:71], v10 offset:18944
    ds_read_b128 v[232:235], v8 offset:32768
    ds_read_b64_tr_b16 v[72:73], v11 offset:16384
    ds_read_b64_tr_b16 v[74:75], v11 offset:16896
    v_mfma_f32_16x16x32_bf16 v[48:51], v[92:95], v[180:183], v[48:51]
    s_lshr_b32 s88, s94, 2
    s_xor_b32 s88, s88, s95
    s_lshl_b32 s89, s88, 16
    s_or_b32 s11, s10, s89
    s_lshl_b32 s89, s88, 18
    s_or_b32 s10, s10, s89
    ds_read_b128 v[236:239], v9 offset:32768
    ds_read_b64_tr_b16 v[76:77], v11 offset:18432
    ds_read_b64_tr_b16 v[78:79], v11 offset:18944
    ds_read_b128 v[80:83], v12 offset:512
    s_waitcnt lgkmcnt(10)
    v_mfma_f32_32x32x16_bf16 v[96:111], v[224:227], v[64:67], v[96:111]
    s_add_u32 m0, s71, 0x1e000
    s_nop 0
    buffer_load_dwordx4 v4, s[36:39], s83 offen lds
    ds_read_b128 v[84:87], v12 offset:544
    s_waitcnt lgkmcnt(8)
    v_mfma_f32_32x32x16_bf16 v[96:111], v[228:231], v[68:71], v[96:111]
    s_add_u32 m0, s71, 0x20000
    s_nop 0
    buffer_load_dwordx4 v4, s[36:39], s84 offen lds
    s_lshl_b32 s88, s13, 12
    s_lshl_b32 s89, s65, 10
    s_or_b32 s13, s88, s89
    s_and_b32 s14, s13, 0x3fff
    s_waitcnt lgkmcnt(5)
    v_mfma_f32_32x32x16_bf16 v[96:111], v[232:235], v[72:75], v[96:111]
    s_add_u32 m0, s71, 0x22000
    s_nop 0
    buffer_load_dwordx4 v4, s[36:39], s85 offen lds
    s_waitcnt lgkmcnt(2)
    v_mfma_f32_32x32x16_bf16 v[96:111], v[236:239], v[76:79], v[96:111]
    s_lshl_b32 s88, s65, 2
    s_add_u32 s88, s88, s93
    s_lshl_b32 s88, s88, 2
    s_add_u32 s88, s88, s73
    s_lshl_b32 s89, s95, 1
    s_add_u32 s8, s88, s89
    s_waitcnt vmcnt(7) lgkmcnt(0)
    s_barrier
    ds_read_b128 v[240:243], v6 offset:49152
    ds_read_b64_tr_b16 v[88:89], v10 offset:24576
    ds_read_b64_tr_b16 v[90:91], v10 offset:25088
    v_mfma_f32_16x16x32_bf16 v[48:51], v[80:83], v[192:195], v[48:51]
    s_xor_b32 s9, s8, 2
    s_mul_i32 s8, s8, 10240
    s_mul_i32 s9, s9, 10240
    s_lshl_b32 s90, s66, 20
    s_add_u32 s8, s8, s90
    s_add_u32 s9, s9, s90
    ds_read_b128 v[244:247], v7 offset:49152
    ds_read_b64_tr_b16 v[92:93], v10 offset:26624
    ds_read_b64_tr_b16 v[94:95], v10 offset:27136
    ds_read_b128 v[248:251], v8 offset:49152
    ds_read_b64_tr_b16 v[64:65], v11 offset:24576
    ds_read_b64_tr_b16 v[66:67], v11 offset:25088
    v_mfma_f32_16x16x32_bf16 v[48:51], v[84:87], v[196:199], v[48:51]
    ds_read_b128 v[252:255], v9 offset:49152
    ds_read_b64_tr_b16 v[68:69], v11 offset:26624
    ds_read_b64_tr_b16 v[70:71], v11 offset:27136
    ds_read_b128 v[72:75], v12 offset:640
    s_waitcnt lgkmcnt(10)
    v_mfma_f32_32x32x16_bf16 v[96:111], v[240:243], v[88:91], v[96:111]
    s_add_u32 m0, s71, 0x24000
    s_nop 0
    buffer_load_dwordx4 v4, s[36:39], s86 offen lds
    s_lshl_b32 s88, s96, 3
    s_add_u32 s88, s88, s64
    s_mul_i32 s88, s88, 12288
    s_lshl_b32 s89, s93, 10
    s_add_u32 s15, s88, s89
    ds_read_b128 v[76:79], v12 offset:672
    ds_read_b128 v[80:83], v12 offset:768
    s_waitcnt lgkmcnt(9)
    v_mfma_f32_32x32x16_bf16 v[96:111], v[244:247], v[92:95], v[96:111]
    s_add_u32 m0, s71, 0x2000
    s_nop 0
    buffer_load_dwordx4 v3, s[36:39], s81 offen lds
    ds_read_b128 v[84:87], v12 offset:800
    ds_read_b128 v[88:91], v12 offset:896
    s_waitcnt lgkmcnt(8)
    v_mfma_f32_32x32x16_bf16 v[96:111], v[248:251], v[64:67], v[96:111]
    s_add_u32 m0, s71, 0x4000
    s_nop 0
    buffer_load_dwordx4 v3, s[36:39], s82 offen lds
    s_waitcnt lgkmcnt(0)
    s_cmp_eq_u32 s74, 0
    s_cbranch_scc1 RT_Qn
OK_Qn:
    v_and_b32 v15, 7, v1
    v_lshrrev_b32_e64 v14, v15, s74
    v_lshrrev_b32 v15, 8, v14
    v_and_b32 v14, s91, v14
    v_and_b32 v15, s91, v15
    v_mov_b32 v2, s74
    s_lshl_b32 s90, s66, 20
    s_add_u32 s15, s15, s90
    s_add_u32 s15, s15, 0xa0000
    s_lshl_b32 s17, s67, 16
    s_add_u32 s17, s17, 0x1000000
    ds_read_b128 v[92:95], v12 offset:928
    v_mfma_f32_32x32x16_bf16 v[96:111], v[252:255], v[68:71], v[96:111]
    v_mfma_f32_16x16x32_bf16 v[48:51], v[72:75], v[208:211], v[48:51]
    s_lshl_b32 s88, s66, 2
    s_add_u32 s88, s88, s65
    s_lshl_b32 s16, s88, 15
    s_lshl_b32 s88, s96, 8
    s_add_u32 s16, s16, s88
    v_mfma_f32_16x16x32_bf16 v[48:51], v[76:79], v[212:215], v[48:51]
    s_waitcnt vmcnt(5) lgkmcnt(0)
    s_barrier
    v_add_u32 v10, 0x8000, v10
    v_add_u32 v11, 0x8000, v11
    ds_read_b64_tr_b16 v[64:65], v10 offset:0
    ds_read_b64_tr_b16 v[66:67], v10 offset:512
    v_mfma_f32_16x16x32_bf16 v[48:51], v[80:83], v[224:227], v[48:51]
    s_add_u32 m0, s71, 0x26000
    s_nop 0
    buffer_load_dwordx4 v4, s[36:39], s87 offen lds
    s_lshl_b32 s88, s93, 6
    s_add_u32 s16, s16, s88
    s_lshl_b32 s88, s73, 5
    s_add_u32 s16, s16, s88
    ds_read_b64_tr_b16 v[68:69], v10 offset:2048
    ds_read_b64_tr_b16 v[70:71], v10 offset:2560
    ds_read_b64_tr_b16 v[72:73], v11 offset:0
    ds_read_b64_tr_b16 v[74:75], v11 offset:512
    v_mfma_f32_16x16x32_bf16 v[48:51], v[84:87], v[228:231], v[48:51]
    s_add_u32 m0, s71, 0x6000
    s_nop 0
    buffer_load_dwordx4 v3, s[36:39], s83 offen lds
    ds_read_b64_tr_b16 v[76:77], v11 offset:2048
    ds_read_b64_tr_b16 v[78:79], v11 offset:2560
    ds_read_b64_tr_b16 v[80:81], v10 offset:8192
    ds_read_b64_tr_b16 v[82:83], v10 offset:8704
    v_mfma_f32_16x16x32_bf16 v[48:51], v[88:91], v[240:243], v[48:51]
    s_add_u32 m0, s71, 0x8000
    s_nop 0
    buffer_load_dwordx4 v3, s[36:39], s84 offen lds
    ds_read_b64_tr_b16 v[84:85], v10 offset:10240
    ds_read_b64_tr_b16 v[86:87], v10 offset:10752
    v_mfma_f32_16x16x32_bf16 v[48:51], v[92:95], v[244:247], v[48:51]
    s_add_u32 m0, s71, 0xa000
    s_nop 0
    buffer_load_dwordx4 v3, s[36:39], s85 offen lds
    ds_read_b64_tr_b16 v[88:89], v11 offset:8192
    ds_read_b64_tr_b16 v[90:91], v11 offset:8704
    s_waitcnt lgkmcnt(12)
    v_mfma_f32_32x32x16_bf16 v[112:127], v[128:131], v[64:67], 0
    s_add_u32 m0, s71, 0xc000
    s_nop 0
    buffer_load_dwordx4 v3, s[36:39], s86 offen lds
    ds_read_b64_tr_b16 v[92:93], v11 offset:10240
    ds_read_b64_tr_b16 v[94:95], v11 offset:10752
    s_waitcnt lgkmcnt(12)
    v_mfma_f32_32x32x16_bf16 v[112:127], v[132:135], v[68:71], v[112:127]
    s_add_u32 m0, s71, 0xe000
    s_nop 0
    buffer_load_dwordx4 v3, s[36:39], s87 offen lds
    v_mov_b32 v19, v48
    v_mul_f32 v32, s97, v96
    v_mul_f32 v33, s97, v97
    v_mul_f32 v34, s97, v98
    v_mul_f32 v35, s97, v99
    ds_read_b64_tr_b16 v[64:65], v10 offset:16384
    ds_read_b64_tr_b16 v[66:67], v10 offset:16896
    s_waitcnt lgkmcnt(12)
    v_mfma_f32_32x32x16_bf16 v[112:127], v[136:139], v[72:75], v[112:127]
    v_mul_f32 v36, s97, v100
    v_mul_f32 v37, s97, v101
    v_mul_f32 v38, s97, v102
    ds_read_b64_tr_b16 v[68:69], v10 offset:18432
    ds_read_b64_tr_b16 v[70:71], v10 offset:18944
    s_waitcnt lgkmcnt(12)
    v_mfma_f32_32x32x16_bf16 v[112:127], v[140:143], v[76:79], v[112:127]
    v_mul_f32 v39, s97, v103
    v_exp_f32_e64 v32, v32 clamp
    ds_read_b64_tr_b16 v[72:73], v11 offset:16384
    ds_read_b64_tr_b16 v[74:75], v11 offset:16896
    s_waitcnt lgkmcnt(12)
    v_mfma_f32_32x32x16_bf16 v[112:127], v[144:147], v[80:83], v[112:127]
    v_exp_f32_e64 v33, v33 clamp
    v_exp_f32_e64 v34, v34 clamp
    ds_read_b64_tr_b16 v[76:77], v11 offset:18432
    ds_read_b64_tr_b16 v[78:79], v11 offset:18944
    s_waitcnt lgkmcnt(12)
    v_mfma_f32_32x32x16_bf16 v[112:127], v[148:151], v[84:87], v[112:127]
    v_exp_f32_e64 v35, v35 clamp
    ds_read_b64_tr_b16 v[80:81], v10 offset:24576
    ds_read_b64_tr_b16 v[82:83], v10 offset:25088
    s_waitcnt lgkmcnt(12)
    v_mfma_f32_32x32x16_bf16 v[112:127], v[152:155], v[88:91], v[112:127]
    v_exp_f32_e64 v36, v36 clamp
    v_exp_f32_e64 v37, v37 clamp
    ds_read_b64_tr_b16 v[84:85], v10 offset:26624
    ds_read_b64_tr_b16 v[86:87], v10 offset:27136
    s_waitcnt lgkmcnt(12)
    v_mfma_f32_32x32x16_bf16 v[112:127], v[156:159], v[92:95], v[112:127]
    v_exp_f32_e64 v38, v38 clamp
    ds_read_b64_tr_b16 v[88:89], v11 offset:24576
    ds_read_b64_tr_b16 v[90:91], v11 offset:25088
    s_waitcnt lgkmcnt(12)
    v_mfma_f32_32x32x16_bf16 v[112:127], v[160:163], v[64:67], v[112:127]
    v_exp_f32_e64 v39, v39 clamp
    v_max_f32 v96, s100, v96
    ds_read_b64_tr_b16 v[92:93], v11 offset:26624
    ds_read_b64_tr_b16 v[94:95], v11 offset:27136
    s_waitcnt lgkmcnt(12)
    v_mfma_f32_32x32x16_bf16 v[112:127], v[164:167], v[68:71], v[112:127]
    v_max_f32 v97, s100, v97
    v_max_f32 v98, s100, v98
    v_max_f32 v99, s100, v99
    s_waitcnt lgkmcnt(10)
    v_mfma_f32_32x32x16_bf16 v[112:127], v[168:171], v[72:75], v[112:127]
    v_max_f32 v100, s100, v100
    v_max_f32 v101, s100, v101
    v_max_f32 v102, s100, v102
    v_max_f32 v103, s100, v103
    s_waitcnt lgkmcnt(8)
    v_mfma_f32_32x32x16_bf16 v[112:127], v[172:175], v[76:79], v[112:127]
    v_add_f32 v96, v32, v96
    v_add_f32 v97, v33, v97
    v_add_f32 v98, v34, v98
    s_waitcnt vmcnt(0) lgkmcnt(0)
    s_barrier
    ds_read_b64_tr_b16 v[64:65], v10 offset:32768
    ds_read_b64_tr_b16 v[66:67], v10 offset:33280
    v_mfma_f32_32x32x16_bf16 v[112:127], v[176:179], v[80:83], v[112:127]
    v_add_f32 v99, v35, v99
    v_add_f32 v100, v36, v100
    v_add_f32 v101, v37, v101
    ds_read_b64_tr_b16 v[68:69], v10 offset:34816
    ds_read_b64_tr_b16 v[70:71], v10 offset:35328
    ds_read_b64_tr_b16 v[72:73], v11 offset:32768
    ds_read_b64_tr_b16 v[74:75], v11 offset:33280
    v_mfma_f32_32x32x16_bf16 v[112:127], v[180:183], v[84:87], v[112:127]
    s_and_b32 s88, s2, 0x78
    s_add_u32 s88, s88, s64
    s_mul_i32 s89, s88, 3584
    s_mul_i32 s90, s93, 458752
    s_add_u32 s89, s89, s90
    v_lshlrev_b32 v22, 7, v1
    s_mov_b64 exec, 0xfffffff
    buffer_load_dword v23, v22, s[40:43], s89 offen
    s_lshl_b32 s89, s88, 10
    s_lshl_b32 s90, s93, 17
    s_add_u32 s89, s89, s90
    s_mov_b64 exec, 0xff
    buffer_load_dword v23, v22, s[44:47], s89 offen
    s_mov_b64 exec, -1
    v_add_f32 v102, v38, v102
    v_add_f32 v103, v39, v103
    v_cvt_pk_bf16_f32 v96, v96, v97
    ds_read_b64_tr_b16 v[76:77], v11 offset:34816
    ds_read_b64_tr_b16 v[78:79], v11 offset:35328
    ds_read_b64_tr_b16 v[80:81], v10 offset:40960
    ds_read_b64_tr_b16 v[82:83], v10 offset:41472
    v_mfma_f32_32x32x16_bf16 v[112:127], v[184:187], v[88:91], v[112:127]
    v_cvt_pk_bf16_f32 v97, v98, v99
    v_cvt_pk_bf16_f32 v98, v100, v101
    v_cvt_pk_bf16_f32 v99, v102, v103
    ds_read_b64_tr_b16 v[84:85], v10 offset:43008
    ds_read_b64_tr_b16 v[86:87], v10 offset:43520
    v_mfma_f32_32x32x16_bf16 v[112:127], v[188:191], v[92:95], v[112:127]
    v_lshrrev_b32 v22, 5, v1
    v_mul_u32_u24 v22, 3584, v22
    v_add_u32 v22, v22, v16
    ds_write_b128 v24, v[96:99] offset:0
    v_mul_f32 v32, s97, v104
    v_mul_f32 v33, s97, v105
    ds_read_b64_tr_b16 v[88:89], v11 offset:40960
    ds_read_b64_tr_b16 v[90:91], v11 offset:41472
    s_waitcnt lgkmcnt(13)
    v_mfma_f32_32x32x16_bf16 v[112:127], v[192:195], v[64:67], v[112:127]
    v_mul_f32 v34, s97, v106
    v_mul_f32 v35, s97, v107
    v_mul_f32 v36, s97, v108
    ds_read_b64_tr_b16 v[92:93], v11 offset:43008
    ds_read_b64_tr_b16 v[94:95], v11 offset:43520
    s_waitcnt lgkmcnt(13)
    v_mfma_f32_32x32x16_bf16 v[112:127], v[196:199], v[68:71], v[112:127]
    v_mul_f32 v37, s97, v109
    v_mul_f32 v38, s97, v110
    v_mul_f32 v39, s97, v111
    ds_read_b64_tr_b16 v[64:65], v10 offset:49152
    ds_read_b64_tr_b16 v[66:67], v10 offset:49664
    s_waitcnt lgkmcnt(13)
    v_mfma_f32_32x32x16_bf16 v[112:127], v[200:203], v[72:75], v[112:127]
    v_exp_f32_e64 v32, v32 clamp
    v_exp_f32_e64 v33, v33 clamp
    ds_read_b64_tr_b16 v[68:69], v10 offset:51200
    ds_read_b64_tr_b16 v[70:71], v10 offset:51712
    s_waitcnt lgkmcnt(13)
    v_mfma_f32_32x32x16_bf16 v[112:127], v[204:207], v[76:79], v[112:127]
    v_exp_f32_e64 v34, v34 clamp
    ds_read_b64_tr_b16 v[72:73], v11 offset:49152
    ds_read_b64_tr_b16 v[74:75], v11 offset:49664
    s_waitcnt lgkmcnt(13)
    v_mfma_f32_32x32x16_bf16 v[112:127], v[208:211], v[80:83], v[112:127]
    v_exp_f32_e64 v35, v35 clamp
    v_exp_f32_e64 v36, v36 clamp
    ds_read_b64_tr_b16 v[76:77], v11 offset:51200
    ds_read_b64_tr_b16 v[78:79], v11 offset:51712
    s_waitcnt lgkmcnt(13)
    v_mfma_f32_32x32x16_bf16 v[112:127], v[212:215], v[84:87], v[112:127]
    v_exp_f32_e64 v37, v37 clamp
    v_exp_f32_e64 v38, v38 clamp
    ds_read_b64_tr_b16 v[80:81], v10 offset:57344
    ds_read_b64_tr_b16 v[82:83], v10 offset:57856
    s_waitcnt lgkmcnt(12)
    v_mfma_f32_32x32x16_bf16 v[112:127], v[216:219], v[88:91], v[112:127]
    v_exp_f32_e64 v39, v39 clamp
    ds_read_b64_tr_b16 v[84:85], v10 offset:59392
    ds_read_b64_tr_b16 v[86:87], v10 offset:59904
    s_waitcnt lgkmcnt(12)
    v_mfma_f32_32x32x16_bf16 v[112:127], v[220:223], v[92:95], v[112:127]
    v_max_f32 v104, s100, v104
    v_max_f32 v105, s100, v105
    v_max_f32 v106, s100, v106
    ds_read_b64_tr_b16 v[88:89], v11 offset:57344
    ds_read_b64_tr_b16 v[90:91], v11 offset:57856
    s_waitcnt lgkmcnt(12)
    v_mfma_f32_32x32x16_bf16 v[112:127], v[224:227], v[64:67], v[112:127]
    v_max_f32 v107, s100, v107
    v_max_f32 v108, s100, v108
    v_max_f32 v109, s100, v109
    ds_read_b64_tr_b16 v[92:93], v11 offset:59392
    ds_read_b64_tr_b16 v[94:95], v11 offset:59904
    s_waitcnt lgkmcnt(12)
    v_mfma_f32_32x32x16_bf16 v[112:127], v[228:231], v[68:71], v[112:127]
    v_max_f32 v110, s100, v110
    v_max_f32 v111, s100, v111
    v_add_f32 v104, v32, v104
    s_waitcnt lgkmcnt(10)
    v_mfma_f32_32x32x16_bf16 v[112:127], v[232:235], v[72:75], v[112:127]
    v_add_f32 v105, v33, v105
    v_add_f32 v106, v34, v106
    v_add_f32 v107, v35, v107
    v_subrev_u32 v10, 0x18000, v10
    v_subrev_u32 v11, 0x18000, v11
    ds_read_b64_tr_b16 v[64:65], v10 offset:0
    ds_read_b64_tr_b16 v[66:67], v10 offset:512
    s_waitcnt lgkmcnt(10)
    v_mfma_f32_32x32x16_bf16 v[112:127], v[236:239], v[76:79], v[112:127]
    v_add_f32 v108, v36, v108
    v_add_f32 v109, v37, v109
    v_add_f32 v110, v38, v110
    ds_read_b64_tr_b16 v[68:69], v10 offset:2048
    ds_read_b64_tr_b16 v[70:71], v10 offset:2560
    s_waitcnt lgkmcnt(10)
    v_mfma_f32_32x32x16_bf16 v[112:127], v[240:243], v[80:83], v[112:127]
    v_add_f32 v111, v39, v111
    v_cvt_pk_bf16_f32 v104, v104, v105
    v_cvt_pk_bf16_f32 v105, v106, v107
    ds_read_b64_tr_b16 v[72:73], v11 offset:0
    ds_read_b64_tr_b16 v[74:75], v11 offset:512
    s_waitcnt lgkmcnt(10)
    v_mfma_f32_32x32x16_bf16 v[112:127], v[244:247], v[84:87], v[112:127]
    v_cvt_pk_bf16_f32 v106, v108, v109
    v_cvt_pk_bf16_f32 v107, v110, v111
    ds_write_b128 v24, v[104:107] offset:1024
    ds_read_b64_tr_b16 v[76:77], v11 offset:2048
    ds_read_b64_tr_b16 v[78:79], v11 offset:2560
    s_waitcnt lgkmcnt(11)
    v_mfma_f32_32x32x16_bf16 v[112:127], v[248:251], v[88:91], v[112:127]
    s_waitcnt lgkmcnt(9)
    v_mfma_f32_32x32x16_bf16 v[112:127], v[252:255], v[92:95], v[112:127]
    s_waitcnt lgkmcnt(7)
    v_mfma_f32_32x32x16_bf16 v[80:95], v[64:67], v[128:131], 0
    s_nop 9
    v_cvt_pk_bf16_f32 v112, v112, v113
    v_cvt_pk_bf16_f32 v113, v114, v115
    v_cvt_pk_bf16_f32 v114, v116, v117
    v_cvt_pk_bf16_f32 v115, v118, v119
    ds_write_b128 v24, v[112:115] offset:16384
    v_cvt_pk_bf16_f32 v120, v120, v121
    v_cvt_pk_bf16_f32 v121, v122, v123
    v_cvt_pk_bf16_f32 v122, v124, v125
    v_cvt_pk_bf16_f32 v123, v126, v127
    ds_write_b128 v24, v[120:123] offset:17408
    s_waitcnt lgkmcnt(0)
    s_barrier
    s_cmp_lg_u32 s73, 0
    s_cbranch_scc1 Q_nojob
    s_setprio 3
    ds_read_b128 v[96:99], v25 offset:0
    ds_read_b128 v[100:103], v25 offset:16384
    ds_read_b128 v[104:107], v25 offset:2048
    ds_read_b128 v[108:111], v25 offset:18432
    ds_read_b128 v[112:115], v25 offset:4096
    ds_read_b128 v[116:119], v25 offset:20480
    ds_read_b128 v[120:123], v25 offset:6144
    ds_read_b128 v[124:127], v25 offset:22528
    s_lshl_b32 s90, s66, 12
    s_add_u32 s90, s90, s71
    s_add_u32 s90, s90, s17
    s_and_b32 s89, s65, 2
    s_lshl_b32 s89, s89, 7
    s_and_b32 s88, s66, 8
    s_lshl_b32 s88, s88, 4
    s_add_u32 s89, s89, s88
    s_lshl_b32 s88, s94, 3
    s_add_u32 s89, s89, s88
    s_and_b32 s88, s65, 1
    s_lshl_b32 s88, s88, 2
    s_add_u32 s89, s89, s88
    s_add_u32 s89, s89, s21
    v_and_b32 v36, 0xf0, v16
    v_bfe_u32 v37, v1, 5, 1
    v_lshl_or_b32 v36, v37, 8, v36
    v_bfe_u32 v37, v1, 4, 1
    v_lshl_or_b32 v36, v37, 3, v36
    s_mov_b32 vcc_lo, 0xffff0000
    s_mov_b32 vcc_hi, vcc_lo
    v_cndmask_b32 v37, v14, v15, vcc
    s_waitcnt lgkmcnt(7)
    v_mfma_f32_16x16x32_bf16 v[52:55], v[96:99], v[60:63], 0
    s_waitcnt lgkmcnt(6)
    v_mfma_f32_16x16x32_bf16 v[48:51], v[96:99], v[100:103], 0
    s_waitcnt lgkmcnt(5)
    v_mfma_f32_16x16x32_bf16 v[52:55], v[104:107], v[60:63], v[52:55]
    s_waitcnt lgkmcnt(4)
    v_mfma_f32_16x16x32_bf16 v[48:51], v[104:107], v[108:111], v[48:51]
    s_waitcnt lgkmcnt(3)
    v_mfma_f32_16x16x32_bf16 v[52:55], v[112:115], v[60:63], v[52:55]
    s_waitcnt lgkmcnt(2)
    v_mfma_f32_16x16x32_bf16 v[48:51], v[112:115], v[116:119], v[48:51]
    s_waitcnt lgkmcnt(1)
    v_mfma_f32_16x16x32_bf16 v[52:55], v[120:123], v[60:63], v[52:55]
    s_waitcnt lgkmcnt(0)
    v_mfma_f32_16x16x32_bf16 v[48:51], v[120:123], v[124:127], v[48:51]
    s_nop 5
    v_cvt_pk_bf16_f32 v34, v52, v53
    v_cvt_pk_bf16_f32 v35, v54, v55
    v_and_or_b32 v34, v34, s75, v37
    buffer_store_dwordx2 v[34:35], v36, s[48:51], s90 offen offset:512 sc1
    v_cvt_pk_bf16_f32 v32, v48, v49
    v_cvt_pk_bf16_f32 v33, v50, v51
    v_and_or_b32 v32, v32, s75, v37
    buffer_store_dwordx2 v[32:33], v36, s[48:51], s90 offen offset:0 sc1
    s_mov_b64 exec, 1
    buffer_store_dword v2, off, s[48:51], s89 sc1
    buffer_store_dword v2, off, s[48:51], s89 offset:512
    s_mov_b64 exec, -1
    s_setprio 0
Q_nojob:
    s_lshr_b32 s88, s65, 1
    s_lshl_b32 s88, s88, 15
    s_add_u32 s17, s17, s88
    s_and_b32 s88, s65, 1
    s_lshl_b32 s89, s73, 1
    s_add_u32 s88, s88, s89
    s_lshl_b32 s88, s88, 10
    s_add_u32 s17, s17, s88
    s_add_u32 s101, s8, 7168
    ds_read_b64_tr_b16 v[64:65], v10 offset:8192
    ds_read_b64_tr_b16 v[66:67], v10 offset:8704
    v_mfma_f32_32x32x16_bf16 v[80:95], v[68:71], v[132:135], v[80:95]
    ds_read_b64_tr_b16 v[68:69], v10 offset:10240
    ds_read_b64_tr_b16 v[70:71], v10 offset:10752
    v_mfma_f32_32x32x16_bf16 v[80:95], v[72:75], v[136:139], v[80:95]
    ds_read_b64_tr_b16 v[72:73], v11 offset:8192
    ds_read_b64_tr_b16 v[74:75], v11 offset:8704
    v_mfma_f32_32x32x16_bf16 v[80:95], v[76:79], v[140:143], v[80:95]
    s_xor_b32 m0, s13, 0x18000
    s_xor_b32 s89, s10, 0x0
    buffer_load_dwordx4 v5, s[40:43], s89 offen lds
    ds_read_b64_tr_b16 v[76:77], v11 offset:10240
    ds_read_b64_tr_b16 v[78:79], v11 offset:10752
    s_waitcnt lgkmcnt(6)
    v_mfma_f32_32x32x16_bf16 v[80:95], v[64:67], v[144:147], v[80:95]
    ds_read_b64_tr_b16 v[64:65], v10 offset:16384
    ds_read_b64_tr_b16 v[66:67], v10 offset:16896
    s_waitcnt lgkmcnt(6)
    v_mfma_f32_32x32x16_bf16 v[80:95], v[68:71], v[148:151], v[80:95]
    s_xor_b32 m0, s13, 0x1a000
    s_xor_b32 s89, s10, 0x8000
    buffer_load_dwordx4 v5, s[40:43], s89 offen lds
    ds_read_b64_tr_b16 v[68:69], v10 offset:18432
    ds_read_b64_tr_b16 v[70:71], v10 offset:18944
    s_waitcnt lgkmcnt(6)
    v_mfma_f32_32x32x16_bf16 v[80:95], v[72:75], v[152:155], v[80:95]
    ds_read_b64_tr_b16 v[72:73], v11 offset:16384
    ds_read_b64_tr_b16 v[74:75], v11 offset:16896
    s_waitcnt lgkmcnt(6)
    v_mfma_f32_32x32x16_bf16 v[80:95], v[76:79], v[156:159], v[80:95]
    s_xor_b32 m0, s13, 0x1c000
    s_xor_b32 s89, s10, 0x40000
    buffer_load_dwordx4 v5, s[40:43], s89 offen lds
    s_lshl_b32 s88, s95, 2
    v_xor_b32 v4, s88, v1
    v_lshl_add_u32 v4, v4, 2, s18
    s_mov_b32 s6, 1
    s_mov_b64 exec, 0xffff
    buffer_load_dword v0, v4, s[48:51], 0 offen sc1
    s_mov_b64 exec, -1
    ds_read_b64_tr_b16 v[76:77], v11 offset:18432
    ds_read_b64_tr_b16 v[78:79], v11 offset:18944
    s_waitcnt lgkmcnt(6)
    v_mfma_f32_32x32x16_bf16 v[80:95], v[64:67], v[160:163], v[80:95]
    s_waitcnt lgkmcnt(4)
    v_mfma_f32_32x32x16_bf16 v[80:95], v[68:71], v[164:167], v[80:95]
    s_xor_b32 m0, s13, 0x1e000
    s_xor_b32 s89, s10, 0x48000
    buffer_load_dwordx4 v5, s[40:43], s89 offen lds
    s_barrier
    ds_read_b64_tr_b16 v[64:65], v10 offset:24576
    ds_read_b64_tr_b16 v[66:67], v10 offset:25088
    s_waitcnt lgkmcnt(4)
    v_mfma_f32_32x32x16_bf16 v[80:95], v[72:75], v[168:171], v[80:95]
    s_xor_b32 m0, s14, 0x14000
    s_xor_b32 s89, s12, 0x30000
    buffer_load_dwordx4 v5, s[40:43], s89 offen lds
    v_bfe_u32 v150, v1, 2, 3
    v_and_b32 v148, 0x1100, v22
    v_lshl_or_b32 v148, v150, 4, v148
    ds_read_b64_tr_b16 v[68:69], v10 offset:26624
    ds_read_b64_tr_b16 v[70:71], v10 offset:27136
    ds_read_b64_tr_b16 v[72:73], v11 offset:24576
    ds_read_b64_tr_b16 v[74:75], v11 offset:25088
    s_waitcnt lgkmcnt(6)
    v_mfma_f32_32x32x16_bf16 v[80:95], v[76:79], v[172:175], v[80:95]
    s_xor_b32 m0, s13, 0x20000
    s_xor_b32 s89, s10, 0x10000
    buffer_load_dwordx4 v5, s[40:43], s89 offen lds
    s_xor_b32 m0, s14, 0x16000
    s_xor_b32 s89, s12, 0x38000
    buffer_load_dwordx4 v5, s[40:43], s89 offen lds
    v_and_b32 v149, 3, v1
    v_lshl_or_b32 v148, v149, 13, v148
    v_lshrrev_b32_e64 v149, v150, s74
    ds_read_b64_tr_b16 v[76:77], v11 offset:26624
    ds_read_b64_tr_b16 v[78:79], v11 offset:27136
    s_waitcnt lgkmcnt(6)
    v_mfma_f32_32x32x16_bf16 v[80:95], v[64:67], v[176:179], v[80:95]
    v_lshrrev_b32 v150, 8, v149
    v_and_b32 v149, s91, v149
    v_and_b32 v150, s91, v150
    s_waitcnt vmcnt(4)
    v_cmp_eq_u32 vcc, s74, v0
    s_and_b32 s22, vcc_lo, 0xffff
    s_and_b32 s88, s22, 0x1100
    s_cmp_eq_u32 s88, 0x1100
    s_cbranch_scc1 ENQQ1
    s_mov_b32 s23, 0x1100
    s_call_b64 s[30:31], SPIN
ENQQ1:
    buffer_load_dwordx4 v[96:99], v16, s[48:51], s8 offen offset:0 sc1
    s_add_u32 s88, s71, 65536
    v_add_u32 v24, s88, v16
    s_lshl_b32 s89, s73, 12
    s_add_u32 s89, s89, 65536
    v_add_u32 v25, s89, v16
    v_lshl_add_u32 v26, v1, 2, s88
    v_xor_b32 v27, 0x1000, v26
    ds_write_b32 v26, v19 offset:8192
    ds_read_b64_tr_b16 v[64:65], v10 offset:32768
    ds_read_b64_tr_b16 v[66:67], v10 offset:33280
    s_waitcnt lgkmcnt(7)
    v_mfma_f32_32x32x16_bf16 v[80:95], v[68:71], v[180:183], v[80:95]
    s_xor_b32 m0, s13, 0x22000
    s_xor_b32 s89, s10, 0x18000
    buffer_load_dwordx4 v5, s[40:43], s89 offen lds
    buffer_load_dwordx4 v[100:103], v16, s[48:51], s8 offen offset:1024 sc1
    s_add_u32 s88, s71, 65536
    v_and_b32 v24, 0xf0, v16
    v_bfe_u32 v151, v1, 4, 1
    v_lshl_or_b32 v24, v151, 9, v24
    v_lshrrev_b32 v151, 5, v1
    v_lshl_or_b32 v24, v151, 3, v24
    v_add_u32 v24, s88, v24
    ds_read_b64_tr_b16 v[68:69], v10 offset:34816
    ds_read_b64_tr_b16 v[70:71], v10 offset:35328
    s_waitcnt lgkmcnt(7)
    v_mfma_f32_32x32x16_bf16 v[80:95], v[72:75], v[184:187], v[80:95]
    buffer_load_dwordx4 v[104:107], v16, s[48:51], s9 offen offset:0 sc1
    s_lshr_b32 s88, s66, 2
    s_xor_b32 s88, s88, s65
    s_bitcmp0_b32 s88, 1
    s_cselect_b32 s89, 1, 0
    s_lshl_b32 s90, s89, 2
    s_lshr_b32 s88, s64, 1
    s_add_u32 s88, s88, s90
    s_lshl_b32 s88, s88, 7
    s_add_u32 s88, s88, s21
    v_lshl_add_u32 v4, v1, 2, s88
    s_mov_b32 s6, s89
    s_mov_b64 exec, 0xffff
    buffer_load_dword v0, v4, s[48:51], 0 offen sc1
    s_mov_b64 exec, -1
    ds_read_b64_tr_b16 v[72:73], v11 offset:32768
    ds_read_b64_tr_b16 v[74:75], v11 offset:33280
    s_waitcnt lgkmcnt(7)
    v_mfma_f32_32x32x16_bf16 v[80:95], v[76:79], v[188:191], v[80:95]
    s_xor_b32 m0, s13, 0x24000
    s_xor_b32 s89, s10, 0x50000
    buffer_load_dwordx4 v5, s[40:43], s89 offen lds
    buffer_load_dwordx4 v[108:111], v16, s[48:51], s9 offen offset:1024 sc1
    ds_read_b64_tr_b16 v[76:77], v11 offset:34816
    ds_read_b64_tr_b16 v[78:79], v11 offset:35328
    s_waitcnt lgkmcnt(6)
    v_mfma_f32_32x32x16_bf16 v[80:95], v[64:67], v[192:195], v[80:95]
    ds_read_b64_tr_b16 v[64:65], v10 offset:40960
    ds_read_b64_tr_b16 v[66:67], v10 offset:41472
    s_waitcnt lgkmcnt(6)
    v_mfma_f32_32x32x16_bf16 v[80:95], v[68:71], v[196:199], v[80:95]
    s_xor_b32 m0, s13, 0x26000
    s_xor_b32 s89, s10, 0x58000
    buffer_load_dwordx4 v5, s[40:43], s89 offen lds
    ds_read_b64_tr_b16 v[68:69], v10 offset:43008
    ds_read_b64_tr_b16 v[70:71], v10 offset:43520
    s_waitcnt lgkmcnt(6)
    v_mfma_f32_32x32x16_bf16 v[80:95], v[72:75], v[200:203], v[80:95]
    ds_read_b64_tr_b16 v[72:73], v11 offset:40960
    ds_read_b64_tr_b16 v[74:75], v11 offset:41472
    s_waitcnt lgkmcnt(6)
    v_mfma_f32_32x32x16_bf16 v[80:95], v[76:79], v[204:207], v[80:95]
    ds_read_b64_tr_b16 v[76:77], v11 offset:43008
    ds_read_b64_tr_b16 v[78:79], v11 offset:43520
    s_waitcnt lgkmcnt(6)
    v_mfma_f32_32x32x16_bf16 v[80:95], v[64:67], v[208:211], v[80:95]
    ds_read_b64_tr_b16 v[64:65], v10 offset:49152
    ds_read_b64_tr_b16 v[66:67], v10 offset:49664
    s_waitcnt lgkmcnt(6)
    v_mfma_f32_32x32x16_bf16 v[80:95], v[68:71], v[212:215], v[80:95]
    s_waitcnt vmcnt(3)
    v_cmp_eq_u32 vcc, s74, v0
    s_and_b32 s22, vcc_lo, 0xffff
    s_and_b32 s88, s22, 0xffff
    s_cmp_eq_u32 s88, 0xffff
    s_cbranch_scc1 ENQQ2
    s_mov_b32 s23, 0xffff
    s_call_b64 s[30:31], SPIN
ENQQ2:
    buffer_load_dwordx4 v[128:131], v148, s[48:51], s17 offen offset:512 sc1
    buffer_load_dwordx4 v[132:135], v22, s[48:51], s17 offen offset:0 sc1
    s_add_u32 s90, s17, 0x2000
    buffer_load_dwordx4 v[136:139], v22, s[48:51], s90 offen offset:0 sc1
    s_add_u32 s90, s17, 0x4000
    buffer_load_dwordx4 v[140:143], v22, s[48:51], s90 offen offset:0 sc1
    s_add_u32 s90, s17, 0x6000
    buffer_load_dwordx4 v[144:147], v22, s[48:51], s90 offen offset:0 sc1
    ds_read_b64_tr_b16 v[68:69], v10 offset:51200
    ds_read_b64_tr_b16 v[70:71], v10 offset:51712
    s_waitcnt lgkmcnt(6)
    v_mfma_f32_32x32x16_bf16 v[80:95], v[72:75], v[216:219], v[80:95]
    ds_read_b64_tr_b16 v[72:73], v11 offset:49152
    ds_read_b64_tr_b16 v[74:75], v11 offset:49664
    s_waitcnt lgkmcnt(6)
    v_mfma_f32_32x32x16_bf16 v[80:95], v[76:79], v[220:223], v[80:95]
    ds_read_b64_tr_b16 v[76:77], v11 offset:51200
    ds_read_b64_tr_b16 v[78:79], v11 offset:51712
    s_waitcnt lgkmcnt(6)
    v_mfma_f32_32x32x16_bf16 v[80:95], v[64:67], v[224:227], v[80:95]
    ds_read_b64_tr_b16 v[64:65], v10 offset:57344
    ds_read_b64_tr_b16 v[66:67], v10 offset:57856
    s_waitcnt lgkmcnt(6)
    v_mfma_f32_32x32x16_bf16 v[80:95], v[68:71], v[228:231], v[80:95]
    ds_read_b64_tr_b16 v[68:69], v10 offset:59392
    ds_read_b64_tr_b16 v[70:71], v10 offset:59904
    s_waitcnt lgkmcnt(6)
    v_mfma_f32_32x32x16_bf16 v[80:95], v[72:75], v[232:235], v[80:95]
    ds_read_b64_tr_b16 v[72:73], v11 offset:57344
    ds_read_b64_tr_b16 v[74:75], v11 offset:57856
    s_waitcnt lgkmcnt(6)
    v_mfma_f32_32x32x16_bf16 v[80:95], v[76:79], v[236:239], v[80:95]
    ds_read_b64_tr_b16 v[76:77], v11 offset:59392
    ds_read_b64_tr_b16 v[78:79], v11 offset:59904
    s_waitcnt lgkmcnt(6)
    v_mfma_f32_32x32x16_bf16 v[80:95], v[64:67], v[240:243], v[80:95]
    s_waitcnt vmcnt(4)
    v_xor_b32 v128, v149, v128
    v_xor_b32 v130, v150, v130
    v_or_b32 v17, v128, v130
    s_nop 0
    v_mfma_f32_16x16x32_bf16 v[52:55], v[56:59], v[128:131], 0
    s_waitcnt vmcnt(3)
    v_xor_b32 v132, v14, v132
    v_xor_b32 v134, v15, v134
    v_or3_b32 v17, v132, v134, v17
    s_nop 0
    v_mfma_f32_16x16x32_bf16 v[48:51], v[56:59], v[132:135], 0
    s_waitcnt vmcnt(2)
    v_xor_b32 v136, v14, v136
    v_xor_b32 v138, v15, v138
    v_or3_b32 v17, v136, v138, v17
    s_nop 0
    v_mfma_f32_16x16x32_bf16 v[48:51], v[56:59], v[136:139], v[48:51]
    v_add_f32_dpp v52, v52, v52 quad_perm:[1,0,3,2] row_mask:0xf bank_mask:0xf
    v_add_f32_dpp v53, v53, v53 quad_perm:[1,0,3,2] row_mask:0xf bank_mask:0xf
    v_add_f32_dpp v54, v54, v54 quad_perm:[1,0,3,2] row_mask:0xf bank_mask:0xf
    v_add_f32_dpp v55, v55, v55 quad_perm:[1,0,3,2] row_mask:0xf bank_mask:0xf
    s_waitcnt vmcnt(1)
    v_xor_b32 v140, v14, v140
    v_xor_b32 v142, v15, v142
    v_or3_b32 v17, v140, v142, v17
    s_nop 0
    v_mfma_f32_16x16x32_bf16 v[48:51], v[56:59], v[140:143], v[48:51]
    v_add_f32_dpp v52, v52, v52 quad_perm:[2,3,0,1] row_mask:0xf bank_mask:0xf
    v_add_f32_dpp v53, v53, v53 quad_perm:[2,3,0,1] row_mask:0xf bank_mask:0xf
    v_add_f32_dpp v54, v54, v54 quad_perm:[2,3,0,1] row_mask:0xf bank_mask:0xf
    v_add_f32_dpp v55, v55, v55 quad_perm:[2,3,0,1] row_mask:0xf bank_mask:0xf
    s_waitcnt vmcnt(0)
    v_xor_b32 v144, v14, v144
    v_xor_b32 v146, v15, v146
    v_or3_b32 v17, v144, v146, v17
    s_nop 0
    v_mfma_f32_16x16x32_bf16 v[48:51], v[56:59], v[144:147], v[48:51]
    v_and_b32 v17, s91, v17
    v_cmp_ne_u32 vcc, 0, v17
    s_nop 0
    s_cmp_lg_u64 vcc, 0
    s_cbranch_scc1 RT_Qkv
OK_Qkv:
    v_cvt_pk_bf16_f32 v34, v52, v53
    v_cvt_pk_bf16_f32 v35, v54, v55
    s_nop 0
    v_cvt_pk_bf16_f32 v32, v48, v49
    v_cvt_pk_bf16_f32 v33, v50, v51
    ds_write2_b64 v24, v[32:33], v[34:35] offset0:0 offset1:32
    s_waitcnt lgkmcnt(0)
    s_barrier
    ds_read_b32 v21, v27 offset:8192
    ds_read_b128 v[128:131], v25 offset:0
    ds_read_b128 v[132:135], v25 offset:1024
    ds_read_b128 v[136:139], v25 offset:2048
    ds_read_b128 v[140:143], v25 offset:3072
    s_lshl_b32 s88, s73, 13
    v_add_u32 v7, s88, v20
    v_xor_b32 v6, 64, v7
    v_add_u32 v8, 98304, v6
    v_add_u32 v9, 98304, v7
    s_lshl_b32 s88, s73, 11
    s_add_u32 s88, s88, 81920
    v_add_u32 v11, s88, v20
    v_xor_b32 v10, 64, v11
    ds_read_b64_tr_b16 v[64:65], v8 offset:0
    ds_read_b64_tr_b16 v[66:67], v8 offset:1024
    v_mfma_f32_32x32x16_bf16 v[80:95], v[68:71], v[244:247], v[80:95]
    s_lshl_b32 s88, s95, 2
    v_xor_b32 v4, s88, v1
    v_lshl_add_u32 v4, v4, 2, s18
    s_mov_b32 s6, 1
    s_mov_b64 exec, 0xffff
    buffer_load_dword v0, v4, s[48:51], 0 offen sc1
    s_mov_b64 exec, -1
    v_xor_b32 v96, v14, v96
    v_xor_b32 v97, v15, v97
    v_or_b32 v17, v96, v97
    v_xor_b32 v100, v14, v100
    v_xor_b32 v101, v15, v101
    s_xor_b32 m0, s13, 0x8000
    s_xor_b32 s89, s11, 0x0
    buffer_load_dwordx4 v13, s[44:47], s89 offen lds
    ds_read_b64_tr_b16 v[68:69], v9 offset:0
    ds_read_b64_tr_b16 v[70:71], v9 offset:1024
    v_mfma_f32_32x32x16_bf16 v[80:95], v[72:75], v[248:251], v[80:95]
    v_or3_b32 v17, v100, v101, v17
    v_xor_b32 v104, v14, v104
    v_xor_b32 v105, v15, v105
    v_or3_b32 v17, v104, v105, v17
    s_xor_b32 m0, s13, 0xa000
    s_xor_b32 s89, s11, 0x8000
    buffer_load_dwordx4 v13, s[44:47], s89 offen lds
    ds_read_b64_tr_b16 v[72:73], v8 offset:4096
    ds_read_b64_tr_b16 v[74:75], v8 offset:5120
    v_mfma_f32_32x32x16_bf16 v[80:95], v[76:79], v[252:255], v[80:95]
    v_xor_b32 v108, v14, v108
    v_xor_b32 v109, v15, v109
    v_or3_b32 v17, v108, v109, v17
    v_and_b32 v17, s91, v17
    v_cmp_ne_u32 vcc, 0, v17
    s_nop 0
    s_cmp_lg_u64 vcc, 0
    s_cbranch_scc1 RT_Qgp
OK_Qgp:
    s_xor_b32 m0, s13, 0xc000
    s_xor_b32 s89, s11, 0x10000
    buffer_load_dwordx4 v13, s[44:47], s89 offen lds
    ds_read_b64_tr_b16 v[76:77], v8 offset:2048
    ds_read_b64_tr_b16 v[78:79], v8 offset:3072
    ds_read_b64_tr_b16 v[184:185], v9 offset:2048
    ds_read_b64_tr_b16 v[186:187], v9 offset:3072
    s_waitcnt lgkmcnt(8)
    v_mfma_f32_32x32x16_bf16 v[192:207], v[64:67], v[96:99], 0
    s_waitcnt vmcnt(3)
    v_cmp_eq_u32 vcc, s74, v0
    s_and_b32 s22, vcc_lo, 0xffff
    s_and_b32 s88, s22, 0x4400
    s_cmp_eq_u32 s88, 0x4400
    s_cbranch_scc1 ENQQ3
    s_mov_b32 s23, 0x4400
    s_call_b64 s[30:31], SPIN
ENQQ3:
    s_add_u32 s90, s8, 0x1000
    buffer_load_dwordx4 v[112:115], v16, s[48:51], s90 offen offset:2048 sc1
    v_mul_f32 v32, s97, v80
    v_mul_f32 v33, s97, v81
    v_mul_f32 v34, s97, v82
    v_mul_f32 v35, s97, v83
    v_mul_f32 v36, s97, v84
    v_mul_f32 v37, s97, v85
    v_mul_f32 v38, s97, v86
    v_mul_f32 v39, s97, v87
    v_exp_f32_e64 v32, v32 clamp
    v_exp_f32_e64 v33, v33 clamp
    v_exp_f32_e64 v34, v34 clamp
    v_exp_f32_e64 v35, v35 clamp
    v_exp_f32_e64 v36, v36 clamp
    s_xor_b32 m0, s13, 0xe000
    s_xor_b32 s89, s11, 0x18000
    buffer_load_dwordx4 v13, s[44:47], s89 offen lds
    ds_read_b64_tr_b16 v[64:65], v8 offset:6144
    ds_read_b64_tr_b16 v[66:67], v8 offset:7168
    s_waitcnt lgkmcnt(8)
    v_mfma_f32_32x32x16_bf16 v[208:223], v[68:71], v[96:99], 0
    s_add_u32 s90, s9, 0x1000
    buffer_load_dwordx4 v[116:119], v16, s[48:51], s90 offen offset:2048 sc1
    v_exp_f32_e64 v37, v37 clamp
    v_exp_f32_e64 v38, v38 clamp
    v_exp_f32_e64 v39, v39 clamp
    v_max_f32 v80, s100, v80
    v_max_f32 v81, s100, v81
    v_max_f32 v82, s100, v82
    v_max_f32 v83, s100, v83
    v_max_f32 v84, s100, v84
    v_max_f32 v85, s100, v85
    v_max_f32 v86, s100, v86
    v_max_f32 v87, s100, v87
    v_add_f32 v80, v32, v80
    v_add_f32 v81, v33, v81
    v_add_f32 v82, v34, v82
    v_add_f32 v83, v35, v83
    ds_read_b64_tr_b16 v[68:69], v8 offset:16384
    ds_read_b64_tr_b16 v[70:71], v8 offset:17408
    s_waitcnt lgkmcnt(8)
    v_mfma_f32_32x32x16_bf16 v[224:239], v[72:75], v[96:99], 0
    buffer_load_dwordx4 v[160:163], v16, s[48:51], s8 offen offset:2048 sc1
    v_add_f32 v84, v36, v84
    v_add_f32 v85, v37, v85
    v_add_f32 v86, v38, v86
    v_add_f32 v87, v39, v87
    v_cvt_pk_bf16_f32 v80, v80, v81
    v_cvt_pk_bf16_f32 v81, v82, v83
    v_cvt_pk_bf16_f32 v82, v84, v85
    v_cvt_pk_bf16_f32 v83, v86, v87
    v_mul_f32 v32, s97, v88
    v_mul_f32 v33, s97, v89
    v_mul_f32 v34, s97, v90
    v_mul_f32 v35, s97, v91
    v_mul_f32 v36, s97, v92
    v_mul_f32 v37, s97, v93
    v_mul_f32 v38, s97, v94
    v_mul_f32 v39, s97, v95
    v_exp_f32_e64 v32, v32 clamp
    ds_read_b64_tr_b16 v[72:73], v9 offset:16384
    ds_read_b64_tr_b16 v[74:75], v9 offset:17408
    s_waitcnt lgkmcnt(8)
    v_mfma_f32_32x32x16_bf16 v[192:207], v[76:79], v[100:103], v[192:207]
    buffer_load_dwordx4 v[164:167], v16, s[48:51], s8 offen offset:3072 sc1
    v_exp_f32_e64 v33, v33 clamp
    v_exp_f32_e64 v34, v34 clamp
    v_exp_f32_e64 v35, v35 clamp
    v_exp_f32_e64 v36, v36 clamp
    v_exp_f32_e64 v37, v37 clamp
    v_exp_f32_e64 v38, v38 clamp
    v_exp_f32_e64 v39, v39 clamp
    v_max_f32 v88, s100, v88
    v_max_f32 v89, s100, v89
    v_max_f32 v90, s100, v90
    ds_read_b64_tr_b16 v[76:77], v8 offset:20480
    ds_read_b64_tr_b16 v[78:79], v8 offset:21504
    s_waitcnt lgkmcnt(8)
    v_mfma_f32_32x32x16_bf16 v[208:223], v[184:187], v[100:103], v[208:223]
    buffer_load_dwordx4 v[168:171], v16, s[48:51], s9 offen offset:2048 sc1
    v_max_f32 v91, s100, v91
    v_max_f32 v92, s100, v92
    v_max_f32 v93, s100, v93
    v_max_f32 v94, s100, v94
    v_max_f32 v95, s100, v95
    v_add_f32 v88, v32, v88
    v_add_f32 v89, v33, v89
    v_add_f32 v90, v34, v90
    v_add_f32 v91, v35, v91
    v_add_f32 v92, v36, v92
    v_add_f32 v93, v37, v93
    v_add_f32 v94, v38, v94
    v_add_f32 v95, v39, v95
    v_cvt_pk_bf16_f32 v88, v88, v89
    v_cvt_pk_bf16_f32 v89, v90, v91
    v_cvt_pk_bf16_f32 v90, v92, v93
    v_cvt_pk_bf16_f32 v91, v94, v95
    ds_read_b64_tr_b16 v[184:185], v8 offset:18432
    ds_read_b64_tr_b16 v[186:187], v8 offset:19456
    s_waitcnt lgkmcnt(8)
    v_mfma_f32_32x32x16_bf16 v[224:239], v[64:67], v[100:103], v[224:239]
    buffer_load_dwordx4 v[172:175], v16, s[48:51], s9 offen offset:3072 sc1
    v_add_f32 v19, v19, v21
    v_mul_f32 v19, s97, v19
    v_min_f32 v19, 0x42640000, v19
    v_exp_f32 v19, v19
    v_mfma_f32_32x32x16_bf16 v[32:47], v[128:131], v[80:83], 0
    v_mfma_f32_32x32x16_bf16 v[48:63], v[132:135], v[88:91], 0
    v_mfma_f32_32x32x16_bf16 v[32:47], v[136:139], v[80:83], v[32:47]
    v_mfma_f32_32x32x16_bf16 v[48:63], v[140:143], v[88:91], v[48:63]
    v_add_f32 v190, 1.0, v19
    v_rcp_f32 v190, v190
    v_mov_b32 v188, v14
    v_mov_b32 v189, v15
    s_nop 6
    v_add_f32 v40, s100, v40
    v_rcp_f32 v40, v40
    s_nop 0
    v_mul_f32 v40, v19, v40
    v_mul_f32 v32, v40, v32
    v_mul_f32 v33, v40, v33
    v_mul_f32 v34, v40, v34
    v_mul_f32 v35, v40, v35
    v_mul_f32 v36, v40, v36
    v_mul_f32 v37, v40, v37
    v_mul_f32 v38, v40, v38
    v_mul_f32 v39, v40, v39
    v_cvt_pk_bf16_f32 v120, v32, v33
    v_cvt_pk_bf16_f32 v121, v34, v35
    v_cvt_pk_bf16_f32 v122, v36, v37
    v_cvt_pk_bf16_f32 v123, v38, v39
    v_and_or_b32 v120, v120, s75, v14
    v_and_or_b32 v121, v121, s75, v15
    buffer_store_dwordx4 v[120:123], v16, s[48:51], s101 offen offset:0 sc1
    v_add_f32 v56, s100, v56
    v_rcp_f32 v56, v56
    s_nop 0
    v_mul_f32 v56, v19, v56
    v_mul_f32 v48, v56, v48
    v_mul_f32 v49, v56, v49
    v_mul_f32 v50, v56, v50
    v_mul_f32 v51, v56, v51
    v_mul_f32 v52, v56, v52
    v_mul_f32 v53, v56, v53
    v_mul_f32 v54, v56, v54
    v_mul_f32 v55, v56, v55
    v_cvt_pk_bf16_f32 v124, v48, v49
    v_cvt_pk_bf16_f32 v125, v50, v51
    v_cvt_pk_bf16_f32 v126, v52, v53
    v_cvt_pk_bf16_f32 v127, v54, v55
    v_and_or_b32 v124, v124, s75, v14
    v_and_or_b32 v125, v125, s75, v15
    buffer_store_dwordx4 v[124:127], v16, s[48:51], s101 offen offset:1024 sc1
    s_mov_b64 exec, 1
    buffer_store_dword v2, off, s[48:51], s19 offset:0
    s_mov_b64 exec, -1
    v_xor_b32 v120, v14, v120
    v_xor_b32 v121, v15, v121
    v_xor_b32 v124, v14, v124
    v_xor_b32 v125, v15, v125
    ds_read_b64_tr_b16 v[64:65], v9 offset:18432
    ds_read_b64_tr_b16 v[66:67], v9 offset:19456
    s_waitcnt lgkmcnt(8)
    v_mfma_f32_32x32x16_bf16 v[192:207], v[68:71], v[104:107], v[192:207]
    ds_read_b64_tr_b16 v[68:69], v8 offset:22528
    ds_read_b64_tr_b16 v[70:71], v8 offset:23552
    s_waitcnt lgkmcnt(8)
    v_mfma_f32_32x32x16_bf16 v[208:223], v[72:75], v[104:107], v[208:223]
    s_xor_b32 m0, s13, 0x0
    s_xor_b32 s89, s10, 0x20000
    buffer_load_dwordx4 v5, s[40:43], s89 offen lds
    ds_read_b64_tr_b16 v[72:73], v10 offset:0
    ds_read_b64_tr_b16 v[74:75], v10 offset:1024
    s_waitcnt lgkmcnt(8)
    v_mfma_f32_32x32x16_bf16 v[224:239], v[76:79], v[104:107], v[224:239]
    buffer_store_dwordx4 v[188:191], v16, s[48:51], s101 offen offset:2048 sc1
    s_waitcnt vmcnt(11)
    v_xor_b32 v112, v14, v112
    v_xor_b32 v113, v15, v113
    v_or_b32 v17, v112, v113
    s_waitcnt vmcnt(9)
    v_xor_b32 v116, v14, v116
    v_xor_b32 v117, v15, v117
    ds_read_b64_tr_b16 v[76:77], v11 offset:0
    ds_read_b64_tr_b16 v[78:79], v11 offset:1024
    s_waitcnt lgkmcnt(8)
    v_mfma_f32_32x32x16_bf16 v[192:207], v[184:187], v[108:111], v[192:207]
    s_xor_b32 m0, s13, 0x2000
    s_xor_b32 s89, s10, 0x28000
    buffer_load_dwordx4 v5, s[40:43], s89 offen lds
    v_or3_b32 v17, v116, v117, v17
    s_waitcnt vmcnt(9)
    v_xor_b32 v160, v14, v160
    v_xor_b32 v161, v15, v161
    v_or3_b32 v17, v160, v161, v17
    s_waitcnt vmcnt(8)
    v_xor_b32 v164, v14, v164
    ds_read_b64_tr_b16 v[184:185], v10 offset:4096
    ds_read_b64_tr_b16 v[186:187], v10 offset:5120
    s_waitcnt lgkmcnt(8)
    v_mfma_f32_32x32x16_bf16 v[208:223], v[64:67], v[108:111], v[208:223]
    v_xor_b32 v165, v15, v165
    v_or3_b32 v17, v164, v165, v17
    s_waitcnt vmcnt(7)
    v_xor_b32 v168, v14, v168
    v_xor_b32 v169, v15, v169
    v_or3_b32 v17, v168, v169, v17
    s_waitcnt vmcnt(6)
    ds_read_b64_tr_b16 v[64:65], v10 offset:8192
    ds_read_b64_tr_b16 v[66:67], v10 offset:9216
    s_waitcnt lgkmcnt(8)
    v_mfma_f32_32x32x16_bf16 v[224:239], v[68:71], v[108:111], v[224:239]
    s_xor_b32 m0, s13, 0x4000
    s_xor_b32 s89, s10, 0x60000
    buffer_load_dwordx4 v5, s[40:43], s89 offen lds
    v_xor_b32 v172, v14, v172
    v_xor_b32 v173, v15, v173
    v_or3_b32 v17, v172, v173, v17
    v_and_b32 v17, s91, v17
    v_cmp_ne_u32 vcc, 0, v17
    s_nop 0
    s_cmp_lg_u64 vcc, 0
    s_cbranch_scc1 RT_Qgq
OK_Qgq:
    ds_read_b64_tr_b16 v[68:69], v11 offset:8192
    ds_read_b64_tr_b16 v[70:71], v11 offset:9216
    s_waitcnt lgkmcnt(8)
    v_mfma_f32_32x32x16_bf16 v[192:207], v[72:75], v[112:115], v[192:207]
    ds_read_b64_tr_b16 v[72:73], v10 offset:12288
    ds_read_b64_tr_b16 v[74:75], v10 offset:13312
    s_waitcnt lgkmcnt(8)
    v_mfma_f32_32x32x16_bf16 v[208:223], v[76:79], v[112:115], v[208:223]
    s_xor_b32 m0, s13, 0x6000
    s_xor_b32 s89, s10, 0x68000
    buffer_load_dwordx4 v5, s[40:43], s89 offen lds
    ds_read_b64_tr_b16 v[76:77], v8 offset:32768
    ds_read_b64_tr_b16 v[78:79], v8 offset:33792
    s_waitcnt lgkmcnt(8)
    v_mfma_f32_32x32x16_bf16 v[224:239], v[184:187], v[112:115], v[224:239]
    ds_read_b64_tr_b16 v[184:185], v9 offset:32768
    ds_read_b64_tr_b16 v[186:187], v9 offset:33792
    s_waitcnt lgkmcnt(8)
    v_mfma_f32_32x32x16_bf16 v[192:207], v[64:67], v[116:119], v[192:207]
    ds_read_b64_tr_b16 v[64:65], v8 offset:36864
    ds_read_b64_tr_b16 v[66:67], v8 offset:37888
    s_waitcnt lgkmcnt(8)
    v_mfma_f32_32x32x16_bf16 v[208:223], v[68:71], v[116:119], v[208:223]
    ds_read_b64_tr_b16 v[68:69], v8 offset:34816
    ds_read_b64_tr_b16 v[70:71], v8 offset:35840
    s_waitcnt lgkmcnt(8)
    v_mfma_f32_32x32x16_bf16 v[224:239], v[72:75], v[116:119], v[224:239]
    ds_read_b64_tr_b16 v[72:73], v9 offset:34816
    ds_read_b64_tr_b16 v[74:75], v9 offset:35840
    s_waitcnt lgkmcnt(8)
    v_mfma_f32_32x32x16_bf16 v[192:207], v[76:79], v[160:163], v[192:207]
    ds_read_b64_tr_b16 v[76:77], v8 offset:38912
    ds_read_b64_tr_b16 v[78:79], v8 offset:39936
    s_waitcnt lgkmcnt(8)
    v_mfma_f32_32x32x16_bf16 v[208:223], v[184:187], v[160:163], v[208:223]
    ds_read_b64_tr_b16 v[184:185], v8 offset:49152
    ds_read_b64_tr_b16 v[186:187], v8 offset:50176
    s_waitcnt lgkmcnt(8)
    v_mfma_f32_32x32x16_bf16 v[224:239], v[64:67], v[160:163], v[224:239]
    ds_read_b64_tr_b16 v[64:65], v9 offset:49152
    ds_read_b64_tr_b16 v[66:67], v9 offset:50176
    s_waitcnt lgkmcnt(8)
    v_mfma_f32_32x32x16_bf16 v[192:207], v[68:71], v[164:167], v[192:207]
    ds_read_b64_tr_b16 v[68:69], v8 offset:53248
    ds_read_b64_tr_b16 v[70:71], v8 offset:54272
    s_waitcnt lgkmcnt(8)
    v_mfma_f32_32x32x16_bf16 v[208:223], v[72:75], v[164:167], v[208:223]
    s_add_u32 s90, s8, 0x1000
    buffer_load_dwordx4 v[144:147], v16, s[48:51], s90 offen offset:0 sc1
    ds_read_b64_tr_b16 v[72:73], v8 offset:51200
    ds_read_b64_tr_b16 v[74:75], v8 offset:52224
    s_waitcnt lgkmcnt(8)
    v_mfma_f32_32x32x16_bf16 v[224:239], v[76:79], v[164:167], v[224:239]
    s_add_u32 s90, s8, 0x1000
    buffer_load_dwordx4 v[148:151], v16, s[48:51], s90 offen offset:1024 sc1
    ds_read_b64_tr_b16 v[76:77], v9 offset:51200
    ds_read_b64_tr_b16 v[78:79], v9 offset:52224
    s_waitcnt lgkmcnt(8)
    v_mfma_f32_32x32x16_bf16 v[192:207], v[184:187], v[168:171], v[192:207]
    s_add_u32 s90, s9, 0x1000
    buffer_load_dwordx4 v[152:155], v16, s[48:51], s90 offen offset:0 sc1
    ds_read_b64_tr_b16 v[184:185], v8 offset:55296
    ds_read_b64_tr_b16 v[186:187], v8 offset:56320
    s_waitcnt lgkmcnt(8)
    v_mfma_f32_32x32x16_bf16 v[208:223], v[64:67], v[168:171], v[208:223]
    s_add_u32 s90, s9, 0x1000
    buffer_load_dwordx4 v[156:159], v16, s[48:51], s90 offen offset:1024 sc1
    s_barrier
    ds_read_b64_tr_b16 v[64:65], v6 offset:32768
    ds_read_b64_tr_b16 v[66:67], v6 offset:33792
    s_waitcnt lgkmcnt(8)
    v_mfma_f32_32x32x16_bf16 v[224:239], v[68:71], v[168:171], v[224:239]
    ds_read_b64_tr_b16 v[68:69], v7 offset:32768
    ds_read_b64_tr_b16 v[70:71], v7 offset:33792
    s_waitcnt lgkmcnt(8)
    v_mfma_f32_32x32x16_bf16 v[192:207], v[72:75], v[172:175], v[192:207]
    ds_read_b64_tr_b16 v[72:73], v6 offset:36864
    ds_read_b64_tr_b16 v[74:75], v6 offset:37888
    s_waitcnt lgkmcnt(8)
    v_mfma_f32_32x32x16_bf16 v[208:223], v[76:79], v[172:175], v[208:223]
    ds_read_b64_tr_b16 v[76:77], v6 offset:34816
    ds_read_b64_tr_b16 v[78:79], v6 offset:35840
    s_waitcnt lgkmcnt(8)
    v_mfma_f32_32x32x16_bf16 v[224:239], v[184:187], v[172:175], v[224:239]
    ds_read_b64_tr_b16 v[184:185], v7 offset:34816
    ds_read_b64_tr_b16 v[186:187], v7 offset:35840
    s_waitcnt lgkmcnt(8)
    v_mfma_f32_32x32x16_bf16 v[192:207], v[64:67], v[120:123], v[192:207]
    s_mov_b64 exec, 0xffff
    buffer_load_dword v0, v4, s[48:51], 0 offen sc1
    s_mov_b64 exec, -1
    ds_read_b64_tr_b16 v[64:65], v6 offset:38912
    ds_read_b64_tr_b16 v[66:67], v6 offset:39936
    s_waitcnt lgkmcnt(8)
    v_mfma_f32_32x32x16_bf16 v[208:223], v[68:71], v[120:123], v[208:223]
    s_lshl_b32 s88, s64, 13
    v_add_u32 v12, s88, v16
    v_xor_b32 v24, 0x8000, v12
    v_and_b32 v25, 31, v1
    v_lshlrev_b32 v25, 10, v25
    v_lshrrev_b32 v3, 5, v1
    v_lshl_add_u32 v25, v3, 4, v25
    s_lshl_b32 s88, s64, 11
    s_add_u32 s88, s88, 65536
    v_add_u32 v3, s88, v16
    v_xor_b32 v26, 0x2000, v3
    v_sub_u32 v27, 3, v1
    v_lshlrev_b32 v27, 7, v27
    v_xor_b32 v27, s20, v27
    v_lshl_add_u32 v27, v1, 2, v27
    v_add_u32 v19, 98304, v12
    v_add_u32 v21, 98304, v24
    s_waitcnt vmcnt(5)
    s_barrier
    ds_read_b64_tr_b16 v[68:69], v6 offset:0
    ds_read_b64_tr_b16 v[70:71], v6 offset:1024
    s_waitcnt lgkmcnt(8)
    v_mfma_f32_32x32x16_bf16 v[224:239], v[72:75], v[120:123], v[224:239]
    s_waitcnt vmcnt(4)
    v_xor_b32 v144, v14, v144
    v_xor_b32 v145, v15, v145
    v_or_b32 v17, v144, v145
    s_waitcnt vmcnt(3)
    ds_read_b64_tr_b16 v[72:73], v7 offset:0
    ds_read_b64_tr_b16 v[74:75], v7 offset:1024
    s_waitcnt lgkmcnt(8)
    v_mfma_f32_32x32x16_bf16 v[192:207], v[76:79], v[124:127], v[192:207]
    v_xor_b32 v148, v14, v148
    v_xor_b32 v149, v15, v149
    v_or3_b32 v17, v148, v149, v17
    s_waitcnt vmcnt(2)
    v_xor_b32 v152, v14, v152
    ds_read_b64_tr_b16 v[76:77], v6 offset:4096
    ds_read_b64_tr_b16 v[78:79], v6 offset:5120
    s_waitcnt lgkmcnt(8)
    v_mfma_f32_32x32x16_bf16 v[208:223], v[184:187], v[124:127], v[208:223]
    s_waitcnt vmcnt(0)
    v_cmp_eq_u32 vcc, s74, v0
    s_and_b32 s22, vcc_lo, 0xffff
    s_and_b32 s88, s22, 0x10
    s_cmp_eq_u32 s88, 0x10
    s_cbranch_scc1 ENQQ4
    s_mov_b32 s23, 0x10
    s_call_b64 s[30:31], SPIN
ENQQ4:
    s_add_u32 s90, s9, 0x1000
    buffer_load_dwordx4 v[176:179], v16, s[48:51], s90 offen offset:3072 sc1
    v_xor_b32 v153, v15, v153
    v_or3_b32 v17, v152, v153, v17
    v_xor_b32 v156, v14, v156
    v_xor_b32 v157, v15, v157
    ds_read_b64_tr_b16 v[184:185], v6 offset:2048
    ds_read_b64_tr_b16 v[186:187], v6 offset:3072
    s_waitcnt lgkmcnt(8)
    v_mfma_f32_32x32x16_bf16 v[224:239], v[64:67], v[124:127], v[224:239]
    s_add_u32 s90, s9, 0x2000
    buffer_load_dwordx4 v[180:183], v16, s[48:51], s90 offen offset:0 sc1
    v_or3_b32 v17, v156, v157, v17
    v_and_b32 v17, s91, v17
    v_cmp_ne_u32 vcc, 0, v17
    s_nop 0
    s_cmp_lg_u64 vcc, 0
    s_cbranch_scc1 RT_Qgc
OK_Qgc:
    ds_read_b64_tr_b16 v[64:65], v7 offset:2048
    ds_read_b64_tr_b16 v[66:67], v7 offset:3072
    s_waitcnt lgkmcnt(8)
    v_mfma_f32_32x32x16_bf16 v[192:207], v[68:71], v[144:147], v[192:207]
    ds_read_b64_tr_b16 v[68:69], v6 offset:6144
    ds_read_b64_tr_b16 v[70:71], v6 offset:7168
    s_waitcnt lgkmcnt(8)
    v_mfma_f32_32x32x16_bf16 v[208:223], v[72:75], v[144:147], v[208:223]
    ds_read_b64_tr_b16 v[72:73], v6 offset:16384
    ds_read_b64_tr_b16 v[74:75], v6 offset:17408
    s_waitcnt lgkmcnt(8)
    v_mfma_f32_32x32x16_bf16 v[224:239], v[76:79], v[144:147], v[224:239]
    ds_read_b64_tr_b16 v[76:77], v7 offset:16384
    ds_read_b64_tr_b16 v[78:79], v7 offset:17408
    s_waitcnt lgkmcnt(8)
    v_mfma_f32_32x32x16_bf16 v[192:207], v[184:187], v[148:151], v[192:207]
    ds_read_b64_tr_b16 v[184:185], v6 offset:20480
    ds_read_b64_tr_b16 v[186:187], v6 offset:21504
    s_waitcnt lgkmcnt(8)
    v_mfma_f32_32x32x16_bf16 v[208:223], v[64:67], v[148:151], v[208:223]
    ds_read_b64_tr_b16 v[64:65], v6 offset:18432
    ds_read_b64_tr_b16 v[66:67], v6 offset:19456
    s_waitcnt lgkmcnt(8)
    v_mfma_f32_32x32x16_bf16 v[224:239], v[68:71], v[148:151], v[224:239]
    ds_read_b64_tr_b16 v[68:69], v7 offset:18432
    ds_read_b64_tr_b16 v[70:71], v7 offset:19456
    s_waitcnt lgkmcnt(8)
    v_mfma_f32_32x32x16_bf16 v[192:207], v[72:75], v[152:155], v[192:207]
    ds_read_b64_tr_b16 v[72:73], v6 offset:22528
    ds_read_b64_tr_b16 v[74:75], v6 offset:23552
    s_waitcnt lgkmcnt(8)
    v_mfma_f32_32x32x16_bf16 v[208:223], v[76:79], v[152:155], v[208:223]
    ds_read_b64_tr_b16 v[76:77], v6 offset:49152
    ds_read_b64_tr_b16 v[78:79], v6 offset:50176
    s_waitcnt lgkmcnt(8)
    v_mfma_f32_32x32x16_bf16 v[224:239], v[184:187], v[152:155], v[224:239]
    ds_read_b64_tr_b16 v[184:185], v7 offset:49152
    ds_read_b64_tr_b16 v[186:187], v7 offset:50176
    s_waitcnt lgkmcnt(8)
    v_mfma_f32_32x32x16_bf16 v[192:207], v[64:67], v[156:159], v[192:207]
    ds_read_b64_tr_b16 v[64:65], v6 offset:53248
    ds_read_b64_tr_b16 v[66:67], v6 offset:54272
    s_waitcnt lgkmcnt(8)
    v_mfma_f32_32x32x16_bf16 v[208:223], v[68:71], v[156:159], v[208:223]
    s_waitcnt vmcnt(1)
    v_xor_b32 v176, v14, v176
    v_xor_b32 v177, v15, v177
    v_or_b32 v17, v176, v177
    s_waitcnt vmcnt(0)
    v_xor_b32 v180, v14, v180
    ds_read_b64_tr_b16 v[68:69], v6 offset:51200
    ds_read_b64_tr_b16 v[70:71], v6 offset:52224
    s_waitcnt lgkmcnt(8)
    v_mfma_f32_32x32x16_bf16 v[224:239], v[72:75], v[156:159], v[224:239]
    v_xor_b32 v181, v15, v181
    v_or3_b32 v17, v180, v181, v17
    v_and_b32 v17, s91, v17
    v_cmp_ne_u32 vcc, 0, v17
    s_nop 0
    s_cmp_lg_u64 vcc, 0
    s_cbranch_scc1 RT_Qgo
OK_Qgo:
    ds_read_b64_tr_b16 v[72:73], v7 offset:51200
    ds_read_b64_tr_b16 v[74:75], v7 offset:52224
    s_waitcnt lgkmcnt(8)
    v_mfma_f32_32x32x16_bf16 v[192:207], v[76:79], v[176:179], v[192:207]
    ds_read_b64_tr_b16 v[76:77], v6 offset:55296
    ds_read_b64_tr_b16 v[78:79], v6 offset:56320
    s_waitcnt lgkmcnt(8)
    v_mfma_f32_32x32x16_bf16 v[208:223], v[184:187], v[176:179], v[208:223]
    ds_read_b64_tr_b16 v[184:185], v9 offset:4096
    ds_read_b64_tr_b16 v[186:187], v9 offset:5120
    s_waitcnt lgkmcnt(8)
    v_mfma_f32_32x32x16_bf16 v[224:239], v[64:67], v[176:179], v[224:239]
    ds_read_b64_tr_b16 v[64:65], v9 offset:6144
    ds_read_b64_tr_b16 v[66:67], v9 offset:7168
    s_waitcnt lgkmcnt(8)
    v_mfma_f32_32x32x16_bf16 v[192:207], v[68:71], v[180:183], v[192:207]
    ds_read_b64_tr_b16 v[68:69], v9 offset:20480
    ds_read_b64_tr_b16 v[70:71], v9 offset:21504
    s_waitcnt lgkmcnt(8)
    v_mfma_f32_32x32x16_bf16 v[208:223], v[72:75], v[180:183], v[208:223]
    ds_read_b64_tr_b16 v[72:73], v9 offset:22528
    ds_read_b64_tr_b16 v[74:75], v9 offset:23552
    s_waitcnt lgkmcnt(8)
    v_mfma_f32_32x32x16_bf16 v[224:239], v[76:79], v[180:183], v[224:239]
    ds_read_b64_tr_b16 v[76:77], v11 offset:4096
    ds_read_b64_tr_b16 v[78:79], v11 offset:5120
    s_waitcnt lgkmcnt(8)
    v_mfma_f32_32x32x16_bf16 v[240:255], v[184:187], v[96:99], 0
    ds_write_b128 v19, v[200:203] offset:0
    ds_write_b128 v19, v[204:207] offset:1024
    s_nop 1
    ds_write_b128 v19, v[216:219] offset:2048
    ds_write_b128 v19, v[220:223] offset:3072
    s_nop 1
    ds_write_b128 v3, v[232:235] offset:0
    ds_write_b128 v3, v[236:239] offset:1024
    ds_read_b64_tr_b16 v[184:185], v11 offset:12288
    ds_read_b64_tr_b16 v[186:187], v11 offset:13312
    s_waitcnt lgkmcnt(14)
    v_mfma_f32_32x32x16_bf16 v[240:255], v[64:67], v[100:103], v[240:255]
    s_waitcnt lgkmcnt(2)
    s_barrier
    ds_read_b128 v[128:131], v21 offset:0
    ds_read_b128 v[132:135], v21 offset:1024
    ds_read_b128 v[136:139], v21 offset:2048
    ds_read_b128 v[140:143], v21 offset:3072
    ds_read_b128 v[32:35], v26 offset:0
    ds_read_b128 v[36:39], v26 offset:1024
    ds_read_b64_tr_b16 v[64:65], v9 offset:36864
    ds_read_b64_tr_b16 v[66:67], v9 offset:37888
    v_mfma_f32_32x32x16_bf16 v[240:255], v[68:71], v[104:107], v[240:255]
    s_xor_b32 s88, s15, 0xc00
    s_waitcnt lgkmcnt(6)
    v_add_f32 v128, v128, v192
    v_add_f32 v129, v129, v193
    v_add_f32 v130, v130, v194
    v_add_f32 v131, v131, v195
    v_add_f32 v132, v132, v196
    v_add_f32 v133, v133, v197
    v_add_f32 v134, v134, v198
    v_add_f32 v135, v135, v199
    v_cvt_pk_bf16_f32 v128, v128, v129
    v_cvt_pk_bf16_f32 v129, v130, v131
    v_cvt_pk_bf16_f32 v130, v132, v133
    v_cvt_pk_bf16_f32 v131, v134, v135
    v_and_or_b32 v128, v128, s75, v14
    v_and_or_b32 v129, v129, s75, v15
    buffer_store_dwordx4 v[128:131], v16, s[48:51], s88 offen offset:0 sc1
    ds_read_b64_tr_b16 v[68:69], v9 offset:38912
    ds_read_b64_tr_b16 v[70:71], v9 offset:39936
    v_mfma_f32_32x32x16_bf16 v[240:255], v[72:75], v[108:111], v[240:255]
    s_xor_b32 s88, s15, 0x800
    s_add_u32 s88, s88, 4096
    s_waitcnt lgkmcnt(6)
    v_add_f32 v136, v136, v208
    v_add_f32 v137, v137, v209
    v_add_f32 v138, v138, v210
    v_add_f32 v139, v139, v211
    v_add_f32 v140, v140, v212
    v_add_f32 v141, v141, v213
    v_add_f32 v142, v142, v214
    v_add_f32 v143, v143, v215
    v_cvt_pk_bf16_f32 v136, v136, v137
    v_cvt_pk_bf16_f32 v137, v138, v139
    v_cvt_pk_bf16_f32 v138, v140, v141
    v_cvt_pk_bf16_f32 v139, v142, v143
    v_and_or_b32 v136, v136, s75, v14
    v_and_or_b32 v137, v137, s75, v15
    buffer_store_dwordx4 v[136:139], v16, s[48:51], s88 offen offset:0 sc1
    ds_read_b64_tr_b16 v[72:73], v9 offset:53248
    ds_read_b64_tr_b16 v[74:75], v9 offset:54272
    v_mfma_f32_32x32x16_bf16 v[240:255], v[76:79], v[112:115], v[240:255]
    s_xor_b32 s88, s15, 0x400
    s_add_u32 s88, s88, 8192
    s_waitcnt lgkmcnt(6)
    v_add_f32 v32, v32, v224
    v_add_f32 v33, v33, v225
    v_add_f32 v34, v34, v226
    v_add_f32 v35, v35, v227
    v_add_f32 v36, v36, v228
    v_add_f32 v37, v37, v229
    v_add_f32 v38, v38, v230
    v_add_f32 v39, v39, v231
    v_cvt_pk_bf16_f32 v32, v32, v33
    v_cvt_pk_bf16_f32 v33, v34, v35
    v_cvt_pk_bf16_f32 v34, v36, v37
    v_cvt_pk_bf16_f32 v35, v38, v39
    v_and_or_b32 v32, v32, s75, v14
    v_and_or_b32 v33, v33, s75, v15
    buffer_store_dwordx4 v[32:35], v16, s[48:51], s88 offen offset:0 sc1
    s_mov_b64 exec, 7
    buffer_store_dword v2, v27, s[48:51], 0 offen sc1
    s_mov_b64 exec, -1
    v_lshl_add_u32 v4, v1, 2, s20
    s_mov_b32 s6, 0
    ds_read_b64_tr_b16 v[76:77], v9 offset:55296
    ds_read_b64_tr_b16 v[78:79], v9 offset:56320
    v_mfma_f32_32x32x16_bf16 v[240:255], v[184:187], v[116:119], v[240:255]
    ds_read_b64_tr_b16 v[184:185], v7 offset:36864
    ds_read_b64_tr_b16 v[186:187], v7 offset:37888
    s_waitcnt lgkmcnt(8)
    v_mfma_f32_32x32x16_bf16 v[240:255], v[64:67], v[160:163], v[240:255]
    ds_read_b64_tr_b16 v[64:65], v7 offset:38912
    ds_read_b64_tr_b16 v[66:67], v7 offset:39936
    s_waitcnt lgkmcnt(8)
    v_mfma_f32_32x32x16_bf16 v[240:255], v[68:71], v[164:167], v[240:255]
    ds_read_b64_tr_b16 v[68:69], v7 offset:4096
    ds_read_b64_tr_b16 v[70:71], v7 offset:5120
    s_waitcnt lgkmcnt(8)
    v_mfma_f32_32x32x16_bf16 v[240:255], v[72:75], v[168:171], v[240:255]
    ds_read_b64_tr_b16 v[72:73], v7 offset:6144
    ds_read_b64_tr_b16 v[74:75], v7 offset:7168
    s_waitcnt lgkmcnt(8)
    v_mfma_f32_32x32x16_bf16 v[240:255], v[76:79], v[172:175], v[240:255]
    ds_read_b64_tr_b16 v[76:77], v7 offset:20480
    ds_read_b64_tr_b16 v[78:79], v7 offset:21504
    s_waitcnt lgkmcnt(8)
    v_mfma_f32_32x32x16_bf16 v[240:255], v[184:187], v[120:123], v[240:255]
    ds_read_b64_tr_b16 v[184:185], v7 offset:22528
    ds_read_b64_tr_b16 v[186:187], v7 offset:23552
    s_waitcnt lgkmcnt(8)
    v_mfma_f32_32x32x16_bf16 v[240:255], v[64:67], v[124:127], v[240:255]
    ds_read_b64_tr_b16 v[64:65], v7 offset:53248
    ds_read_b64_tr_b16 v[66:67], v7 offset:54272
    s_waitcnt lgkmcnt(8)
    v_mfma_f32_32x32x16_bf16 v[240:255], v[68:71], v[144:147], v[240:255]
    ds_read_b64_tr_b16 v[68:69], v7 offset:55296
    ds_read_b64_tr_b16 v[70:71], v7 offset:56320
    s_waitcnt lgkmcnt(8)
    v_mfma_f32_32x32x16_bf16 v[240:255], v[72:75], v[148:151], v[240:255]
    s_waitcnt lgkmcnt(6)
    v_mfma_f32_32x32x16_bf16 v[240:255], v[76:79], v[152:155], v[240:255]
    s_waitcnt lgkmcnt(4)
    v_mfma_f32_32x32x16_bf16 v[240:255], v[184:187], v[156:159], v[240:255]
    s_waitcnt lgkmcnt(2)
    v_mfma_f32_32x32x16_bf16 v[240:255], v[64:67], v[176:179], v[240:255]
    s_waitcnt lgkmcnt(0)
    v_mfma_f32_32x32x16_bf16 v[240:255], v[68:71], v[180:183], v[240:255]
    s_mov_b64 exec, 0xffff
    buffer_load_dword v0, v4, s[48:51], 0 offen sc1
    s_mov_b64 exec, -1
    s_nop 8
    ds_write_b128 v12, v[248:251] offset:0
    ds_write_b128 v12, v[252:255] offset:1024
    s_waitcnt lgkmcnt(0)
    s_barrier
    ds_read_b128 v[40:43], v24 offset:0
    ds_read_b128 v[44:47], v24 offset:1024
    s_waitcnt vmcnt(0)
    v_cmp_eq_u32 vcc, s74, v0
    s_and_b32 s22, vcc_lo, 0xffff
    s_and_b32 s88, s22, 0x7
    s_cmp_eq_u32 s88, 0x7
    s_cbranch_scc1 ENQQ5
    s_mov_b32 s23, 0x7
    s_call_b64 s[30:31], SPIN
ENQQ5:
    buffer_load_dwordx4 v[52:55], v16, s[48:51], s15 offen offset:0 sc1
    s_add_u32 s90, s15, 0x1000
    buffer_load_dwordx4 v[56:59], v16, s[48:51], s90 offen offset:0 sc1
    s_add_u32 s90, s15, 0x2000
    buffer_load_dwordx4 v[60:63], v16, s[48:51], s90 offen offset:0 sc1
    s_waitcnt lgkmcnt(0)
    v_mul_f32 v40, v190, v40
    v_mul_f32 v41, v190, v41
    v_mul_f32 v42, v190, v42
    v_mul_f32 v43, v190, v43
    v_mul_f32 v44, v190, v44
    v_mul_f32 v45, v190, v45
    v_mul_f32 v46, v190, v46
    v_mul_f32 v47, v190, v47
    s_waitcnt vmcnt(2)
    v_xor_b32 v52, v14, v52
    v_xor_b32 v53, v15, v53
    v_or_b32 v17, v52, v53
    s_nop 0
    v_mfma_f32_32x32x16_bf16 v[192:207], v[28:31], v[52:55], v[240:255]
    s_waitcnt vmcnt(1)
    v_xor_b32 v56, v14, v56
    v_xor_b32 v57, v15, v57
    v_or3_b32 v17, v56, v57, v17
    s_nop 0
    v_mfma_f32_32x32x16_bf16 v[192:207], v[28:31], v[56:59], v[192:207]
    s_waitcnt vmcnt(0)
    v_xor_b32 v60, v14, v60
    v_xor_b32 v61, v15, v61
    v_or3_b32 v17, v60, v61, v17
    s_nop 0
    v_mfma_f32_32x32x16_bf16 v[192:207], v[28:31], v[60:63], v[192:207]
    v_and_b32 v17, s91, v17
    v_cmp_ne_u32 vcc, 0, v17
    s_nop 0
    s_cmp_lg_u64 vcc, 0
    s_cbranch_scc1 RT_Qpr
OK_Qpr:
    s_nop 6
    v_fmac_f32 v40, v190, v192
    v_fmac_f32 v41, v190, v193
    v_fmac_f32 v42, v190, v194
    v_fmac_f32 v43, v190, v195
    v_fmac_f32 v44, v190, v196
    v_fmac_f32 v45, v190, v197
    v_fmac_f32 v46, v190, v198
    v_fmac_f32 v47, v190, v199
    v_cvt_pk_bf16_f32 v40, v40, v41
    v_cvt_pk_bf16_f32 v41, v42, v43
    v_cvt_pk_bf16_f32 v42, v44, v45
    v_cvt_pk_bf16_f32 v43, v46, v47
    buffer_store_dwordx4 v[40:43], v25, s[52:55], s16 offen
    s_endpgm
RT_Wn:
    s_add_u32 s92, s92, 1
    s_cmp_gt_u32 s92, 20000
    s_cbranch_scc1 OK_Wn
    buffer_load_dword v14, off, s[60:63], 0 sc1
    s_waitcnt vmcnt(0)
    v_readfirstlane_b32 s74, v14
    s_nop 0
    s_cmp_eq_u32 s74, 0
    s_cbranch_scc1 RT_Wn
    s_branch OK_Wn
RT_Wga:
    s_add_u32 s92, s92, 1
    s_and_b32 s88, s92, 0xffff
    s_cmp_gt_u32 s88, 20000
    s_cbranch_scc1 OK_Wga
    s_sleep 1
    buffer_load_dwordx4 v[128:131], v16, s[48:51], s9 offen offset:0 sc1
    buffer_load_dwordx4 v[132:135], v16, s[48:51], s9 offen offset:1024 sc1
    s_waitcnt vmcnt(0)
    v_xor_b32 v128, v14, v128
    v_xor_b32 v129, v15, v129
    v_or_b32 v17, v128, v129
    v_xor_b32 v132, v14, v132
    v_xor_b32 v133, v15, v133
    v_or3_b32 v17, v132, v133, v17
    v_and_b32 v17, s91, v17
    v_cmp_ne_u32 vcc, 0, v17
    s_nop 0
    s_cmp_lg_u64 vcc, 0
    s_cbranch_scc1 RT_Wga
    s_branch OK_Wga
RT_Wgq:
    s_add_u32 s92, s92, 1
    s_and_b32 s88, s92, 0xffff
    s_cmp_gt_u32 s88, 20000
    s_cbranch_scc1 OK_Wgq
    s_sleep 1
    buffer_load_dwordx4 v[140:143], v16, s[48:51], s9 offen offset:2048 sc1
    buffer_load_dwordx4 v[144:147], v16, s[48:51], s9 offen offset:3072 sc1
    s_add_u32 s90, s9, 0x1000
    buffer_load_dwordx4 v[136:139], v16, s[48:51], s90 offen offset:2048 sc1
    s_waitcnt vmcnt(0)
    v_xor_b32 v140, v14, v140
    v_xor_b32 v141, v15, v141
    v_or_b32 v17, v140, v141
    v_xor_b32 v144, v14, v144
    v_xor_b32 v145, v15, v145
    v_or3_b32 v17, v144, v145, v17
    v_xor_b32 v136, v14, v136
    v_xor_b32 v137, v15, v137
    v_or3_b32 v17, v136, v137, v17
    v_and_b32 v17, s91, v17
    v_cmp_ne_u32 vcc, 0, v17
    s_nop 0
    s_cmp_lg_u64 vcc, 0
    s_cbranch_scc1 RT_Wgq
    s_branch OK_Wgq
RT_Wgc:
    s_add_u32 s92, s92, 1
    s_and_b32 s88, s92, 0xffff
    s_cmp_gt_u32 s88, 20000
    s_cbranch_scc1 OK_Wgc
    s_sleep 1
    s_add_u32 s90, s9, 0x1000
    buffer_load_dwordx4 v[148:151], v16, s[48:51], s90 offen offset:0 sc1
    s_add_u32 s90, s9, 0x1000
    buffer_load_dwordx4 v[152:155], v16, s[48:51], s90 offen offset:1024 sc1
    s_waitcnt vmcnt(0)
    v_xor_b32 v148, v14, v148
    v_xor_b32 v149, v15, v149
    v_or_b32 v17, v148, v149
    v_xor_b32 v152, v14, v152
    v_xor_b32 v153, v15, v153
    v_or3_b32 v17, v152, v153, v17
    v_and_b32 v17, s91, v17
    v_cmp_ne_u32 vcc, 0, v17
    s_nop 0
    s_cmp_lg_u64 vcc, 0
    s_cbranch_scc1 RT_Wgc
    s_branch OK_Wgc
RT_Wgo:
    s_add_u32 s92, s92, 1
    s_and_b32 s88, s92, 0xffff
    s_cmp_gt_u32 s88, 20000
    s_cbranch_scc1 OK_Wgo
    s_sleep 1
    s_add_u32 s90, s8, 0x1000
    buffer_load_dwordx4 v[156:159], v16, s[48:51], s90 offen offset:3072 sc1
    s_add_u32 s90, s8, 0x2000
    buffer_load_dwordx4 v[160:163], v16, s[48:51], s90 offen offset:0 sc1
    s_add_u32 s90, s9, 0x1000
    buffer_load_dwordx4 v[164:167], v16, s[48:51], s90 offen offset:3072 sc1
    s_add_u32 s90, s9, 0x2000
    buffer_load_dwordx4 v[168:171], v16, s[48:51], s90 offen offset:0 sc1
    s_waitcnt vmcnt(0)
    v_xor_b32 v156, v14, v156
    v_xor_b32 v157, v15, v157
    v_or_b32 v17, v156, v157
    v_xor_b32 v160, v14, v160
    v_xor_b32 v161, v15, v161
    v_or3_b32 v17, v160, v161, v17
    v_xor_b32 v164, v14, v164
    v_xor_b32 v165, v15, v165
    v_or3_b32 v17, v164, v165, v17
    v_xor_b32 v168, v14, v168
    v_xor_b32 v169, v15, v169
    v_or3_b32 v17, v168, v169, v17
    v_and_b32 v17, s91, v17
    v_cmp_ne_u32 vcc, 0, v17
    s_nop 0
    s_cmp_lg_u64 vcc, 0
    s_cbranch_scc1 RT_Wgo
    s_branch OK_Wgo
RT_Wgp:
    s_add_u32 s92, s92, 1
    s_and_b32 s88, s92, 0xffff
    s_cmp_gt_u32 s88, 20000
    s_cbranch_scc1 OK_Wgp
    s_sleep 1
    s_add_u32 s90, s8, 0x2000
    buffer_load_dwordx4 v[172:175], v16, s[48:51], s90 offen offset:1024 sc1
    s_waitcnt vmcnt(0)
    v_xor_b32 v172, v14, v172
    v_xor_b32 v173, v15, v173
    v_or_b32 v17, v172, v173
    v_and_b32 v17, s91, v17
    v_cmp_ne_u32 vcc, 0, v17
    s_nop 0
    s_cmp_lg_u64 vcc, 0
    s_cbranch_scc1 RT_Wgp
    s_branch OK_Wgp
RT_Wpr:
    s_add_u32 s92, s92, 1
    s_and_b32 s88, s92, 0xffff
    s_cmp_gt_u32 s88, 20000
    s_cbranch_scc1 OK_Wpr
    s_sleep 1
    buffer_load_dwordx4 v[52:55], v16, s[48:51], s15 offen offset:0 sc1
    s_add_u32 s90, s15, 0x1000
    buffer_load_dwordx4 v[56:59], v16, s[48:51], s90 offen offset:0 sc1
    s_add_u32 s90, s15, 0x2000
    buffer_load_dwordx4 v[60:63], v16, s[48:51], s90 offen offset:0 sc1
    s_waitcnt vmcnt(0)
    v_xor_b32 v52, v14, v52
    v_xor_b32 v53, v15, v53
    v_or_b32 v17, v52, v53
    s_nop 0
    v_mfma_f32_32x32x16_bf16 v[192:207], v[100:103], v[52:55], v[240:255]
    v_xor_b32 v56, v14, v56
    v_xor_b32 v57, v15, v57
    v_or3_b32 v17, v56, v57, v17
    s_nop 0
    v_mfma_f32_32x32x16_bf16 v[192:207], v[100:103], v[56:59], v[192:207]
    v_xor_b32 v60, v14, v60
    v_xor_b32 v61, v15, v61
    v_or3_b32 v17, v60, v61, v17
    s_nop 0
    v_mfma_f32_32x32x16_bf16 v[192:207], v[100:103], v[60:63], v[192:207]
    v_and_b32 v17, s91, v17
    v_cmp_ne_u32 vcc, 0, v17
    s_nop 0
    s_cmp_lg_u64 vcc, 0
    s_nop 15
    s_cbranch_scc1 RT_Wpr
    s_branch OK_Wpr
RT_Qn:
    s_add_u32 s92, s92, 1
    s_cmp_gt_u32 s92, 20000
    s_cbranch_scc1 OK_Qn
    buffer_load_dword v14, off, s[60:63], 0 sc1
    s_waitcnt vmcnt(0)
    v_readfirstlane_b32 s74, v14
    s_nop 0
    s_cmp_eq_u32 s74, 0
    s_cbranch_scc1 RT_Qn
    s_branch OK_Qn
RT_Qkv:
    s_add_u32 s92, s92, 1
    s_and_b32 s88, s92, 0xffff
    s_cmp_gt_u32 s88, 20000
    s_cbranch_scc1 OK_Qkv
    s_sleep 1
    buffer_load_dwordx4 v[128:131], v148, s[48:51], s17 offen offset:512 sc1
    buffer_load_dwordx4 v[132:135], v22, s[48:51], s17 offen offset:0 sc1
    s_add_u32 s90, s17, 0x2000
    buffer_load_dwordx4 v[136:139], v22, s[48:51], s90 offen offset:0 sc1
    s_add_u32 s90, s17, 0x4000
    buffer_load_dwordx4 v[140:143], v22, s[48:51], s90 offen offset:0 sc1
    s_add_u32 s90, s17, 0x6000
    buffer_load_dwordx4 v[144:147], v22, s[48:51], s90 offen offset:0 sc1
    s_waitcnt vmcnt(0)
    v_xor_b32 v128, v149, v128
    v_xor_b32 v130, v150, v130
    v_or_b32 v17, v128, v130
    s_nop 0
    v_mfma_f32_16x16x32_bf16 v[52:55], v[56:59], v[128:131], 0
    v_xor_b32 v132, v14, v132
    v_xor_b32 v134, v15, v134
    v_or3_b32 v17, v132, v134, v17
    s_nop 0
    v_mfma_f32_16x16x32_bf16 v[48:51], v[56:59], v[132:135], 0
    v_xor_b32 v136, v14, v136
    v_xor_b32 v138, v15, v138
    v_or3_b32 v17, v136, v138, v17
    s_nop 0
    v_mfma_f32_16x16x32_bf16 v[48:51], v[56:59], v[136:139], v[48:51]
    v_add_f32_dpp v52, v52, v52 quad_perm:[1,0,3,2] row_mask:0xf bank_mask:0xf
    v_add_f32_dpp v53, v53, v53 quad_perm:[1,0,3,2] row_mask:0xf bank_mask:0xf
    v_add_f32_dpp v54, v54, v54 quad_perm:[1,0,3,2] row_mask:0xf bank_mask:0xf
    v_add_f32_dpp v55, v55, v55 quad_perm:[1,0,3,2] row_mask:0xf bank_mask:0xf
    v_xor_b32 v140, v14, v140
    v_xor_b32 v142, v15, v142
    v_or3_b32 v17, v140, v142, v17
    s_nop 0
    v_mfma_f32_16x16x32_bf16 v[48:51], v[56:59], v[140:143], v[48:51]
    v_add_f32_dpp v52, v52, v52 quad_perm:[2,3,0,1] row_mask:0xf bank_mask:0xf
    v_add_f32_dpp v53, v53, v53 quad_perm:[2,3,0,1] row_mask:0xf bank_mask:0xf
    v_add_f32_dpp v54, v54, v54 quad_perm:[2,3,0,1] row_mask:0xf bank_mask:0xf
    v_add_f32_dpp v55, v55, v55 quad_perm:[2,3,0,1] row_mask:0xf bank_mask:0xf
    v_xor_b32 v144, v14, v144
    v_xor_b32 v146, v15, v146
    v_or3_b32 v17, v144, v146, v17
    s_nop 0
    v_mfma_f32_16x16x32_bf16 v[48:51], v[56:59], v[144:147], v[48:51]
    v_and_b32 v17, s91, v17
    v_cmp_ne_u32 vcc, 0, v17
    s_nop 0
    s_cmp_lg_u64 vcc, 0
    s_nop 15
    s_cbranch_scc1 RT_Qkv
    s_branch OK_Qkv
RT_Qgp:
    s_add_u32 s92, s92, 1
    s_and_b32 s88, s92, 0xffff
    s_cmp_gt_u32 s88, 20000
    s_cbranch_scc1 OK_Qgp
    s_sleep 1
    buffer_load_dwordx4 v[96:99], v16, s[48:51], s8 offen offset:0 sc1
    buffer_load_dwordx4 v[100:103], v16, s[48:51], s8 offen offset:1024 sc1
    buffer_load_dwordx4 v[104:107], v16, s[48:51], s9 offen offset:0 sc1
    buffer_load_dwordx4 v[108:111], v16, s[48:51], s9 offen offset:1024 sc1
    s_waitcnt vmcnt(0)
    v_xor_b32 v96, v14, v96
    v_xor_b32 v97, v15, v97
    v_or_b32 v17, v96, v97
    v_xor_b32 v100, v14, v100
    v_xor_b32 v101, v15, v101
    v_or3_b32 v17, v100, v101, v17
    v_xor_b32 v104, v14, v104
    v_xor_b32 v105, v15, v105
    v_or3_b32 v17, v104, v105, v17
    v_xor_b32 v108, v14, v108
    v_xor_b32 v109, v15, v109
    v_or3_b32 v17, v108, v109, v17
    v_and_b32 v17, s91, v17
    v_cmp_ne_u32 vcc, 0, v17
    s_nop 0
    s_cmp_lg_u64 vcc, 0
    s_cbranch_scc1 RT_Qgp
    s_branch OK_Qgp
RT_Qgq:
    s_add_u32 s92, s92, 1
    s_and_b32 s88, s92, 0xffff
    s_cmp_gt_u32 s88, 20000
    s_cbranch_scc1 OK_Qgq
    s_sleep 1
    s_add_u32 s90, s8, 0x1000
    buffer_load_dwordx4 v[112:115], v16, s[48:51], s90 offen offset:2048 sc1
    s_add_u32 s90, s9, 0x1000
    buffer_load_dwordx4 v[116:119], v16, s[48:51], s90 offen offset:2048 sc1
    buffer_load_dwordx4 v[160:163], v16, s[48:51], s8 offen offset:2048 sc1
    buffer_load_dwordx4 v[164:167], v16, s[48:51], s8 offen offset:3072 sc1
    buffer_load_dwordx4 v[168:171], v16, s[48:51], s9 offen offset:2048 sc1
    buffer_load_dwordx4 v[172:175], v16, s[48:51], s9 offen offset:3072 sc1
    s_waitcnt vmcnt(0)
    v_xor_b32 v112, v14, v112
    v_xor_b32 v113, v15, v113
    v_or_b32 v17, v112, v113
    v_xor_b32 v116, v14, v116
    v_xor_b32 v117, v15, v117
    v_or3_b32 v17, v116, v117, v17
    v_xor_b32 v160, v14, v160
    v_xor_b32 v161, v15, v161
    v_or3_b32 v17, v160, v161, v17
    v_xor_b32 v164, v14, v164
    v_xor_b32 v165, v15, v165
    v_or3_b32 v17, v164, v165, v17
    v_xor_b32 v168, v14, v168
    v_xor_b32 v169, v15, v169
    v_or3_b32 v17, v168, v169, v17
    v_xor_b32 v172, v14, v172
    v_xor_b32 v173, v15, v173
    v_or3_b32 v17, v172, v173, v17
    v_and_b32 v17, s91, v17
    v_cmp_ne_u32 vcc, 0, v17
    s_nop 0
    s_cmp_lg_u64 vcc, 0
    s_cbranch_scc1 RT_Qgq
    s_branch OK_Qgq
RT_Qgc:
    s_add_u32 s92, s92, 1
    s_and_b32 s88, s92, 0xffff
    s_cmp_gt_u32 s88, 20000
    s_cbranch_scc1 OK_Qgc
    s_sleep 1
    s_add_u32 s90, s8, 0x1000
    buffer_load_dwordx4 v[144:147], v16, s[48:51], s90 offen offset:0 sc1
    s_add_u32 s90, s8, 0x1000
    buffer_load_dwordx4 v[148:151], v16, s[48:51], s90 offen offset:1024 sc1
    s_add_u32 s90, s9, 0x1000
    buffer_load_dwordx4 v[152:155], v16, s[48:51], s90 offen offset:0 sc1
    s_add_u32 s90, s9, 0x1000
    buffer_load_dwordx4 v[156:159], v16, s[48:51], s90 offen offset:1024 sc1
    s_waitcnt vmcnt(0)
    v_xor_b32 v144, v14, v144
    v_xor_b32 v145, v15, v145
    v_or_b32 v17, v144, v145
    v_xor_b32 v148, v14, v148
    v_xor_b32 v149, v15, v149
    v_or3_b32 v17, v148, v149, v17
    v_xor_b32 v152, v14, v152
    v_xor_b32 v153, v15, v153
    v_or3_b32 v17, v152, v153, v17
    v_xor_b32 v156, v14, v156
    v_xor_b32 v157, v15, v157
    v_or3_b32 v17, v156, v157, v17
    v_and_b32 v17, s91, v17
    v_cmp_ne_u32 vcc, 0, v17
    s_nop 0
    s_cmp_lg_u64 vcc, 0
    s_cbranch_scc1 RT_Qgc
    s_branch OK_Qgc
RT_Qgo:
    s_add_u32 s92, s92, 1
    s_and_b32 s88, s92, 0xffff
    s_cmp_gt_u32 s88, 20000
    s_cbranch_scc1 OK_Qgo
    s_sleep 1
    s_add_u32 s90, s9, 0x1000
    buffer_load_dwordx4 v[176:179], v16, s[48:51], s90 offen offset:3072 sc1
    s_add_u32 s90, s9, 0x2000
    buffer_load_dwordx4 v[180:183], v16, s[48:51], s90 offen offset:0 sc1
    s_waitcnt vmcnt(0)
    v_xor_b32 v176, v14, v176
    v_xor_b32 v177, v15, v177
    v_or_b32 v17, v176, v177
    v_xor_b32 v180, v14, v180
    v_xor_b32 v181, v15, v181
    v_or3_b32 v17, v180, v181, v17
    v_and_b32 v17, s91, v17
    v_cmp_ne_u32 vcc, 0, v17
    s_nop 0
    s_cmp_lg_u64 vcc, 0
    s_cbranch_scc1 RT_Qgo
    s_branch OK_Qgo
RT_Qpr:
    s_add_u32 s92, s92, 1
    s_and_b32 s88, s92, 0xffff
    s_cmp_gt_u32 s88, 20000
    s_cbranch_scc1 OK_Qpr
    s_sleep 1
    buffer_load_dwordx4 v[52:55], v16, s[48:51], s15 offen offset:0 sc1
    s_add_u32 s90, s15, 0x1000
    buffer_load_dwordx4 v[56:59], v16, s[48:51], s90 offen offset:0 sc1
    s_add_u32 s90, s15, 0x2000
    buffer_load_dwordx4 v[60:63], v16, s[48:51], s90 offen offset:0 sc1
    s_waitcnt vmcnt(0)
    v_xor_b32 v52, v14, v52
    v_xor_b32 v53, v15, v53
    v_or_b32 v17, v52, v53
    s_nop 0
    v_mfma_f32_32x32x16_bf16 v[192:207], v[28:31], v[52:55], v[240:255]
    v_xor_b32 v56, v14, v56
    v_xor_b32 v57, v15, v57
    v_or3_b32 v17, v56, v57, v17
    s_nop 0
    v_mfma_f32_32x32x16_bf16 v[192:207], v[28:31], v[56:59], v[192:207]
    v_xor_b32 v60, v14, v60
    v_xor_b32 v61, v15, v61
    v_or3_b32 v17, v60, v61, v17
    s_nop 0
    v_mfma_f32_32x32x16_bf16 v[192:207], v[28:31], v[60:63], v[192:207]
    v_and_b32 v17, s91, v17
    v_cmp_ne_u32 vcc, 0, v17
    s_nop 0
    s_cmp_lg_u64 vcc, 0
    s_nop 15
    s_cbranch_scc1 RT_Qpr
    s_branch OK_Qpr
CODE_END:
    s_endpgm
.section .rodata,"a"
.p2align 6
.amdhsa_kernel gated_mix__linear_attn_block__dense_activation_mish__prompt_kernel
  .amdhsa_next_free_vgpr 256
  .amdhsa_next_free_sgpr 102
  .amdhsa_accum_offset 256
  .amdhsa_group_segment_fixed_size 0
  .amdhsa_kernarg_size 88
  .amdhsa_user_sgpr_count 2
  .amdhsa_user_sgpr_kernarg_segment_ptr 1
  .amdhsa_system_sgpr_workgroup_id_x 1
.end_amdhsa_kernel
```
